```python
import torch

def _softmax(x, axis=-1):
    return torch.softmax(x, dim=axis)

def _gelu(x):
    return torch.nn.functional.gelu(x, approximate='tanh')

def _silu(x):
    return torch.nn.functional.silu(x)

def _sigmoid(x):
    return torch.sigmoid(x)

def _layernorm(x, axis=-1, eps=1e-05):
    m = x.mean(dim=axis, keepdim=True)
    v = x.var(dim=axis, keepdim=True, unbiased=False)
    return (x - m) / torch.sqrt(v + eps)

def _scatter_add(tgt, idx, src, axis=0):
    return tgt.clone().index_add_(axis, idx, src)

def _segment_sum(src, seg, n):
    out = torch.zeros((n,) + src.shape[1:], dtype=src.dtype)
    return out.index_add_(0, seg, src)

def _pad(x, pw):
    flat = tuple((v for pair in reversed(pw) for v in pair))
    return torch.nn.functional.pad(x, flat)
kernel_name = 'adaLN_cond__sliding_local_dilated__dense_activation_silu__prompt'

def setup_inputs():

    _w = lambda a: (lambda t: t.to(torch.bfloat16) if t.is_floating_point() else t)(torch.as_tensor(a))

    def _A_setup():
        B, S, D = (1, 2048, 512)
        return {'x': _w((lambda *s: torch.randn(*s, dtype=torch.bfloat16) * 0.05)(B, S, D)), 'wqkv': _w((lambda *s: torch.randn(*s, dtype=torch.bfloat16) * 0.05)(D, 3 * D)), 'wo': _w((lambda *s: torch.randn(*s, dtype=torch.bfloat16) * 0.05)(D, D))}
    _A_in = _A_setup()

    def _B_setup():
        B, S, D, F = (1, 2048, 512, 1376)
        return {'x': _w((lambda *s: torch.randn(*s, dtype=torch.bfloat16) * 0.05)(B, S, D)), 'w1': _w((lambda *s: torch.randn(*s, dtype=torch.bfloat16) * 3.2)(D, F) * D ** (-0.5)), 'w2': _w((lambda *s: torch.randn(*s, dtype=torch.bfloat16) * 0.4)(F, D) * F ** (-0.5))}
    _B_in = _B_setup()
    return {'A_x': _A_in['x'], 'A_wqkv': _A_in['wqkv'], 'A_wo': _A_in['wo'], 'B_x': _B_in['x'], 'B_w1': _B_in['w1'], 'B_w2': _B_in['w2'], 'c': _w((lambda *s: torch.randn(*s, dtype=torch.bfloat16) * 0.1)(1, 512) * 8.0), 'w_mod': _w((lambda *s: torch.randn(*s, dtype=torch.bfloat16) * 0.1)(512, 6 * 512) * 512 ** (-0.5) * 8.0)}

def reference(A_x, A_wqkv, A_wo, B_x, B_w1, B_w2, c, w_mod):

    def _A_ref(x, wqkv, wo):
        B, S, D = x.shape
        H = 32
        Dh = D // H
        W, dil = (8, 2)
        qkv = (lambda x, *d: x.permute(*d))((x @ wqkv).reshape(B, S, 3, H, Dh), 2, 0, 3, 1, 4)
        q, k, v = (qkv[0], qkv[1], qkv[2])
        scale = Dh ** (-0.5)
        pos = torch.arange(S)
        off = torch.arange(W) * dil
        idx = pos[:, None] - off[None, :]
        mask = idx >= 0
        idx_c = torch.where(mask, idx, 0).reshape(-1)
        kg = k[:, :, idx_c, :].reshape(B, H, S, W, Dh)
        vg = v[:, :, idx_c, :].reshape(B, H, S, W, Dh)
        logits = torch.einsum('bhsd,bhswd->bhsw', q, kg) * scale
        logits = torch.where(mask[None, None, :, :], logits, -1000000000.0)
        attn = _softmax(logits, axis=-1)
        o = torch.einsum('bhsw,bhswd->bhsd', attn, vg)
        return (lambda x, *d: x.permute(*d))(o, 0, 2, 1, 3).reshape(B, S, D) @ wo

    def _B_ref(x, w1, w2):
        h = torch.einsum('bsd,df->bsf', x, w1)
        h = _silu(h)
        out = torch.einsum('bsf,fd->bsd', h, w2)
        return out
    x = A_x
    mod = (_silu(c) @ w_mod).reshape(c.shape[0], 6, 1, -1)
    sa, ca, ga, sb, cb, gb = (mod[:, 0].clone(), mod[:, 1].clone(), mod[:, 2].clone(), mod[:, 3].clone(), mod[:, 4].clone(), mod[:, 5].clone())
    h = _layernorm(x, axis=-1) * (1 + ca) + sa
    x = x + ga * _A_ref(h, A_wqkv, A_wo)
    h = _layernorm(x, axis=-1) * (1 + cb) + sb
    x = x + gb * _B_ref(h, B_w1, B_w2)
    return x
```

```asm
; @launch grid=(256,1,1) block=(256,1,1) lds=163840
.set PFO_all, 1024
.set PFN_all, 31
.set PF_LAST, 32512
.amdgcn_target "amdgcn-amd-amdhsa--gfx950"
.text
.globl adaLN_cond__sliding_local_dilated__dense_activation_silu__prompt_kernel
.p2align 8
.type adaLN_cond__sliding_local_dilated__dense_activation_silu__prompt_kernel,@function
adaLN_cond__sliding_local_dilated__dense_activation_silu__prompt_kernel:
    s_cbranch_execz L_disp
    s_cmp_ge_u32 s2, 256
    s_cbranch_scc0 L_main
    s_endpgm
L_disp:
    s_setpc_b64 s[22:23]
L_main:
    s_getpc_b64 s[24:25]
    s_load_dwordx2 s[32:33], s[0:1], 0
    s_load_dwordx2 s[52:53], s[0:1], 48
    s_load_dwordx2 s[56:57], s[0:1], 56
    s_load_dwordx2 s[28:29], s[0:1], 80
    s_load_dwordx2 s[36:37], s[0:1], 8
    s_load_dwordx2 s[40:41], s[0:1], 16
    s_load_dwordx2 s[44:45], s[0:1], 32
    s_load_dwordx2 s[48:49], s[0:1], 40
    s_load_dwordx2 s[92:93], s[0:1], 64
    v_and_b32 v1, 63, v0
    v_lshrrev_b32 v2, 6, v0
    s_nop 0
    v_readfirstlane_b32 s3, v2
    v_lshlrev_b32 v2, 4, v1
    s_and_b32 s4, s2, 7
    s_lshr_b32 s5, s2, 3
    s_mov_b32 s30, 0x1500000
    s_mov_b32 s31, 0x00020000
    s_mov_b32 s34, 0x200000
    s_mov_b32 s35, 0x00020000
    s_mov_b32 s54, 0x400
    s_mov_b32 s55, 0x00020000
    s_mov_b32 s58, 0x300000
    s_mov_b32 s59, 0x00020000
    s_mov_b32 s38, 0x180000
    s_mov_b32 s39, 0x00020000
    s_mov_b32 s42, 0x80000
    s_mov_b32 s43, 0x00020000
    s_lshr_b32 s99, s5, 2
    s_lshl_b32 s99, s99, 1
    s_and_b32 s19, s5, 1
    s_add_u32 s99, s99, s19
    s_lshr_b32 s18, s99, 2
    s_lshl_b32 s18, s18, 6
    s_lshl_b32 s19, s19, 5
    s_add_u32 s18, s18, s19
    s_cbranch_execz L_disp
    s_bfe_u32 s19, s99, 0x10001
    s_add_u32 s18, s18, s19
    s_lshl_b32 s19, s3, 3
    s_add_u32 s18, s18, s19
    s_lshl_b32 s19, s4, 8
    s_add_u32 s18, s18, s19
    s_lshl_b32 s18, s18, 10
    s_sub_i32 s19, s19, 16
    s_max_i32 s19, s19, 0
    s_add_u32 s19, s19, s99
    s_lshl_b32 s19, s19, 10
    s_add_u32 s17, s18, 4096
    s_and_b32 s97, s99, 3
    s_lshr_b32 s20, s99, 2
    s_lshl_b32 s21, s4, 2
    s_add_u32 s21, s21, s20
    s_lshl_b32 s22, s4, 2
    s_lshr_b32 s22, 0x46750321, s22
    s_and_b32 s22, s22, 7
    s_lshl_b32 s22, s22, 2
    s_add_u32 s22, s22, s20
    s_lshl_b32 s22, s22, 1
    s_add_u32 s22, s22, s97
    s_add_u32 s22, s22, 30
    s_cmp_eq_u32 s97, 0
    s_cselect_b32 s98, s21, s22
    s_lshl_b32 s20, s98, 6
    s_mul_i32 s21, s3, 786432
    s_add_u32 s20, s20, s21
    s_lshl_b32 s21, s3, 8
    v_lshrrev_b32 v3, 2, v1
    v_mul_u32_u24 v3, 3072, v3
    v_and_b32 v6, 3, v1
    v_lshl_add_u32 v3, v6, 4, v3
    s_and_b32 s96, s5, 3
    s_and_b32 s22, s5, 7
    s_cmp_eq_u32 s22, 2
    s_cselect_b32 s96, 1, s96
    s_lshl_b32 s22, s96, 2
    s_add_u32 s22, s22, s3
    s_mul_i32 s26, s22, 98304
    s_lshr_b32 s22, s5, 1
    s_lshl_b32 s22, s22, 6
    s_add_u32 s26, s26, s22
    s_lshl_b32 s27, s3, 11
    v_lshrrev_b32 v9, 2, v1
    v_mul_u32_u24 v8, 49152, v9
    v_lshlrev_b32 v9, 4, v9
    v_lshl_add_u32 v8, v6, 4, v8
    s_waitcnt lgkmcnt(0)
    s_and_b32 s33, s33, 0xffff
    s_and_b32 s53, s53, 0xffff
    s_cbranch_execz L_disp
    s_and_b32 s57, s57, 0xffff
    s_and_b32 s29, s29, 0xffff
    s_and_b32 s37, s37, 0xffff
    s_and_b32 s41, s41, 0xffff
    buffer_load_dword v5, off, s[28:31], 0 sc1
    s_bitcmp1_b32 s5, 1
    s_cbranch_scc1 L_issT
    buffer_load_dwordx4 v[10:13], v2, s[32:35], s18 offen
    buffer_load_dwordx4 v[14:17], v2, s[32:35], s18 offen offset:2048
    buffer_load_dwordx4 v[18:21], v2, s[32:35], s17 offen
    buffer_load_dwordx4 v[22:25], v2, s[32:35], s17 offen offset:2048
    buffer_load_dwordx4 v[26:29], v2, s[32:35], s19 offen
    s_branch L_issJ
L_issT:
    s_cmp_eq_u32 s97, 0
    s_cbranch_scc1 L_issG
    s_add_u32 m0, s27, 0x0
    s_add_u32 s23, s26, 0x0
    buffer_load_dwordx4 v3, s[36:39], s23 offen offset:0  lds
    s_add_u32 s23, s26, 0xbc00
    buffer_load_dwordx4 v3, s[36:39], s23 offen offset:1024  lds
    s_add_u32 m0, s27, 0x2000
    s_add_u32 s23, s26, 0x400
    buffer_load_dwordx4 v3, s[36:39], s23 offen offset:0  lds
    s_add_u32 s23, s26, 0xc000
    buffer_load_dwordx4 v3, s[36:39], s23 offen offset:1024  lds
    s_add_u32 m0, s27, 0x4000
    s_add_u32 s23, s26, 0x800
    buffer_load_dwordx4 v3, s[36:39], s23 offen offset:0  lds
    s_add_u32 s23, s26, 0xc400
    buffer_load_dwordx4 v3, s[36:39], s23 offen offset:1024  lds
    s_cmp_eq_u32 s97, 1
    s_cbranch_scc1 L_issH
    buffer_load_dwordx4 v[10:13], v9, s[52:55], s21 offen
    buffer_load_dwordx4 v[64:67], v8, s[56:59], s20 offen
    s_add_u32 s20, s20, 6144
    buffer_load_dwordx4 v[68:71], v8, s[56:59], s20 offen
    s_cbranch_execz L_disp
    s_add_u32 s20, s20, 6144
    buffer_load_dwordx4 v[72:75], v8, s[56:59], s20 offen
    s_add_u32 s20, s20, 6144
    buffer_load_dwordx4 v[76:79], v8, s[56:59], s20 offen
    s_add_u32 s20, s20, 6144
    buffer_load_dwordx4 v[80:83], v8, s[56:59], s20 offen
    s_add_u32 s20, s20, 6144
    buffer_load_dwordx4 v[84:87], v8, s[56:59], s20 offen
    s_add_u32 s20, s20, 6144
    buffer_load_dwordx4 v[88:91], v8, s[56:59], s20 offen
    s_add_u32 s20, s20, 6144
    buffer_load_dwordx4 v[92:95], v8, s[56:59], s20 offen
L_issH:
    s_and_b32 s24, s24, 0xffffff00
    s_and_b32 s16, s99, 12
    s_add_u32 s17, s16, s3
    s_add_u32 s17, s17, 4
    s_lshl_b32 s16, s16, 1
    s_lshl_b32 s18, s97, 2
    s_add_u32 s16, s16, s18
    s_add_u32 s16, s16, s3
    s_add_u32 s16, s16, 60
    s_cmp_eq_u32 s97, 1
    s_cselect_b32 s16, s17, s16
    s_cselect_b32 s17, 16, 32
    s_cselect_b32 s1, 0, 64
    s_add_u32 s1, s1, 68
L_hops:
    s_lshl_b32 s18, s16, 8
    s_min_u32 s18, s18, PF_LAST
    s_add_u32 s18, s24, s18
    s_addc_u32 s19, s25, 0
    s_mov_b64 exec, 0
    s_swappc_b64 s[22:23], s[18:19]
    s_mov_b64 exec, -1
    s_add_u32 s16, s16, s17
    s_cmp_lt_u32 s16, s1
    s_cbranch_scc1 L_hops
    s_branch L_issJ
L_issG:
    buffer_load_dwordx4 v[10:13], v9, s[52:55], s21 offen
    buffer_load_dwordx4 v[64:67], v8, s[56:59], s20 offen
    s_add_u32 s20, s20, 6144
    buffer_load_dwordx4 v[68:71], v8, s[56:59], s20 offen
    s_add_u32 s20, s20, 6144
    s_nop 0
    s_cbranch_execz L_disp
    buffer_load_dwordx4 v[72:75], v8, s[56:59], s20 offen
    s_add_u32 s20, s20, 6144
    buffer_load_dwordx4 v[76:79], v8, s[56:59], s20 offen
    s_add_u32 s20, s20, 6144
    buffer_load_dwordx4 v[80:83], v8, s[56:59], s20 offen
    s_add_u32 s20, s20, 6144
    buffer_load_dwordx4 v[84:87], v8, s[56:59], s20 offen
    s_add_u32 s20, s20, 6144
    buffer_load_dwordx4 v[88:91], v8, s[56:59], s20 offen
    s_add_u32 s20, s20, 6144
    buffer_load_dwordx4 v[92:95], v8, s[56:59], s20 offen
L_issJ:
    s_and_b32 s45, s45, 0xffff
    s_mov_b32 s46, 0x158000
    s_mov_b32 s47, 0x00020000
    s_and_b32 s49, s49, 0xffff
    s_mov_b32 s50, 0x158000
    s_mov_b32 s51, 0x00020000
    s_and_b32 s93, s93, 0xffff
    s_mov_b32 s94, 0x200000
    s_mov_b32 s95, 0x00020000
    s_and_b32 s7, s5, 1
    s_lshr_b32 s8, s5, 1
    s_lshl_b32 s9, s4, 3
    s_lshl_b32 s20, s7, 2
    s_add_u32 s9, s9, s20
    s_add_u32 s9, s9, s3
    s_lshl_b32 s10, s4, 2
    s_and_b32 s20, s5, 3
    s_add_u32 s10, s10, s20
    s_lshr_b32 s11, s5, 2
    s_and_b32 s12, s3, 1
    s_lshr_b32 s13, s3, 1
    s_lshl_b32 s14, s10, 1
    s_add_u32 s14, s14, s12
    s_lshl_b32 s15, s11, 1
    s_add_u32 s15, s15, s13
    s_mov_b32 s16, 16
    v_lshrrev_b32 v6, 5, v1
    v_lshlrev_b32 v253, 9, v6
    v_bfe_u32 v6, v1, 2, 2
    v_lshl_add_u32 v253, v6, 6, v253
    s_cbranch_execz L_disp
    v_bfe_u32 v6, v1, 4, 1
    v_lshl_add_u32 v253, v6, 5, v253
    v_and_b32 v6, 1, v1
    v_lshl_add_u32 v253, v6, 4, v253
    v_bfe_u32 v6, v1, 1, 1
    v_lshl_add_u32 v253, v6, 3, v253
    v_bfe_u32 v251, v1, 4, 1
    v_lshlrev_b32 v251, 3, v251
    v_lshrrev_b32 v250, 5, v1
    v_lshl_add_u32 v251, v250, 2, v251
    s_lshl_b32 s21, s3, 7
    s_add_u32 s21, s21, 0x1c000
    v_add_u32 v251, s21, v251
    v_and_b32 v250, 3, v1
    v_lshl_add_u32 v251, v250, 5, v251
    v_and_b32 v250, 31, v1
    v_lshlrev_b32 v250, 2, v250
    s_mov_b32 s0, 0
    s_mov_b32 s1, 0
    s_bitcmp1_b32 s5, 1
    s_nop 1
    s_cbranch_scc1 L_roleT
    v_mov_b32 v103, 0x3f803f80
    v_mov_b32 v102, 0x3b000000
    s_lshl_b32 s21, s3, 2
    v_and_b32 v6, 15, v1
    v_xor_b32 v124, s21, v6
    v_lshlrev_b32 v124, 4, v124
    v_lshl_add_u32 v124, v1, 8, v124
    v_add_u32 v124, 0x18000, v124
    v_xor_b32 v125, 16, v124
    v_xor_b32 v126, 32, v124
    v_xor_b32 v127, 48, v124
    v_lshrrev_b32 v7, 4, v1
    v_xor_b32 v128, v6, v7
    v_lshlrev_b32 v128, 4, v128
    v_lshl_add_u32 v128, v7, 8, v128
    s_lshl_b32 s21, s3, 12
    s_add_u32 s21, s21, 0x18000
    v_add_u32 v128, s21, v128
    v_xor_b32 v129, 64, v128
    v_xor_b32 v130, 128, v128
    v_xor_b32 v131, 192, v128
    v_lshlrev_b32 v132, 4, v6
    v_lshl_add_u32 v132, v7, 9, v132
    s_cbranch_execz L_disp
    v_lshlrev_b32 v133, 9, v1
    s_mul_i32 s20, s4, 327680
    s_add_u32 s20, s20, 0x100000
    s_add_u32 s21, s11, 2
    s_lshl_b32 s21, s21, 15
    s_add_u32 s21, s21, s20
    s_lshl_b32 s22, s7, 8
    s_add_u32 s21, s21, s22
    s_lshl_b32 s22, s3, 13
    s_add_u32 s21, s21, s22
    s_add_u32 s24, s21, 4096
    s_lshl_b32 s23, s7, 15
    s_add_u32 s23, s23, s20
    s_add_u32 s22, s11, 24
    s_lshl_b32 s22, s22, 4
    s_add_u32 s23, s23, s22
    s_lshl_b32 s25, s4, 8
    s_lshl_b32 s22, s99, 4
    s_add_u32 s25, s25, s22
    s_lshl_b32 s22, s3, 2
    s_add_u32 s25, s25, s22
    s_add_u32 s1, s25, 0x1000
    s_waitcnt vmcnt(4)
    v_readfirstlane_b32 s6, v5
    s_nop 0
    s_mul_i32 s6, s6, 0x9E3779B1
    s_add_u32 s6, s6, 0x7F4A7C15
    v_mov_b32 v254, s6
    v_dot2_f32_bf16 v92, v10, v103, 0
    v_dot2_f32_bf16 v93, v10, v10, 0
    s_nop 1
    v_dot2c_f32_bf16 v92, v11, v103
    v_dot2c_f32_bf16 v93, v11, v11
    v_dot2c_f32_bf16 v92, v12, v103
    v_dot2c_f32_bf16 v93, v12, v12
    v_dot2c_f32_bf16 v92, v13, v103
    v_dot2c_f32_bf16 v93, v13, v13
    s_waitcnt vmcnt(3)
    v_dot2_f32_bf16 v94, v14, v103, 0
    v_dot2_f32_bf16 v95, v14, v14, 0
    s_nop 1
    v_dot2c_f32_bf16 v94, v15, v103
    v_dot2c_f32_bf16 v95, v15, v15
    v_dot2c_f32_bf16 v94, v16, v103
    v_dot2c_f32_bf16 v95, v16, v16
    v_dot2c_f32_bf16 v94, v17, v103
    v_dot2c_f32_bf16 v95, v17, v17
    s_waitcnt vmcnt(2)
    v_dot2_f32_bf16 v96, v18, v103, 0
    v_dot2_f32_bf16 v97, v18, v18, 0
    s_nop 1
    s_cbranch_execz L_disp
    v_dot2c_f32_bf16 v96, v19, v103
    v_dot2c_f32_bf16 v97, v19, v19
    v_dot2c_f32_bf16 v96, v20, v103
    v_dot2c_f32_bf16 v97, v20, v20
    v_dot2c_f32_bf16 v96, v21, v103
    v_dot2c_f32_bf16 v97, v21, v21
    s_waitcnt vmcnt(1)
    v_dot2_f32_bf16 v98, v22, v103, 0
    v_dot2_f32_bf16 v99, v22, v22, 0
    s_nop 1
    v_dot2c_f32_bf16 v98, v23, v103
    v_dot2c_f32_bf16 v99, v23, v23
    v_dot2c_f32_bf16 v98, v24, v103
    v_dot2c_f32_bf16 v99, v24, v24
    v_dot2c_f32_bf16 v98, v25, v103
    v_dot2c_f32_bf16 v99, v25, v25
    s_waitcnt vmcnt(0)
    v_dot2_f32_bf16 v100, v26, v103, 0
    v_dot2_f32_bf16 v101, v26, v26, 0
    s_nop 1
    v_dot2c_f32_bf16 v100, v27, v103
    v_dot2c_f32_bf16 v101, v27, v27
    v_dot2c_f32_bf16 v100, v28, v103
    v_dot2c_f32_bf16 v101, v28, v28
    v_dot2c_f32_bf16 v100, v29, v103
    v_dot2c_f32_bf16 v101, v29, v29
    v_permlane16_swap_b32 v92, v93
    v_permlane16_swap_b32 v94, v95
    v_permlane16_swap_b32 v96, v97
    v_permlane16_swap_b32 v98, v99
    v_permlane16_swap_b32 v100, v101
    v_add_f32 v92, v92, v93
    v_add_f32 v94, v94, v95
    v_add_f32 v96, v96, v97
    v_add_f32 v98, v98, v99
    v_add_f32 v100, v100, v101
    v_mov_b32 v101, v100
    v_permlane32_swap_b32 v92, v94
    v_permlane32_swap_b32 v96, v98
    v_permlane32_swap_b32 v100, v101
    v_add_f32 v92, v92, v94
    v_add_f32 v96, v96, v98
    v_add_f32 v100, v100, v101
    v_add_f32_dpp v92, v92, v92 row_ror:1 row_mask:0xf bank_mask:0xf
    v_add_f32_dpp v96, v96, v96 row_ror:1 row_mask:0xf bank_mask:0xf
    v_add_f32_dpp v100, v100, v100 row_ror:1 row_mask:0xf bank_mask:0xf
    v_lshlrev_b32 v32, 16, v10
    v_and_b32 v33, 0xffff0000, v10
    v_lshlrev_b32 v34, 16, v11
    v_and_b32 v35, 0xffff0000, v11
    v_add_f32_dpp v92, v92, v92 row_ror:2 row_mask:0xf bank_mask:0xf
    v_add_f32_dpp v96, v96, v96 row_ror:2 row_mask:0xf bank_mask:0xf
    s_cbranch_execz L_disp
    v_add_f32_dpp v100, v100, v100 row_ror:2 row_mask:0xf bank_mask:0xf
    v_lshlrev_b32 v36, 16, v12
    v_and_b32 v37, 0xffff0000, v12
    v_lshlrev_b32 v38, 16, v13
    v_and_b32 v39, 0xffff0000, v13
    v_add_f32_dpp v92, v92, v92 row_ror:4 row_mask:0xf bank_mask:0xf
    v_add_f32_dpp v96, v96, v96 row_ror:4 row_mask:0xf bank_mask:0xf
    v_add_f32_dpp v100, v100, v100 row_ror:4 row_mask:0xf bank_mask:0xf
    v_lshlrev_b32 v40, 16, v14
    v_and_b32 v41, 0xffff0000, v14
    v_lshlrev_b32 v42, 16, v15
    v_and_b32 v43, 0xffff0000, v15
    v_add_f32_dpp v92, v92, v92 row_ror:8 row_mask:0xf bank_mask:0xf
    v_add_f32_dpp v96, v96, v96 row_ror:8 row_mask:0xf bank_mask:0xf
    v_add_f32_dpp v100, v100, v100 row_ror:8 row_mask:0xf bank_mask:0xf
    v_lshlrev_b32 v44, 16, v16
    v_and_b32 v45, 0xffff0000, v16
    v_lshlrev_b32 v46, 16, v17
    v_and_b32 v47, 0xffff0000, v17
    v_readlane_b32 s60, v92, 0
    v_readlane_b32 s61, v92, 16
    v_readlane_b32 s62, v92, 32
    v_readlane_b32 s63, v92, 48
    v_readlane_b32 s64, v96, 0
    v_readlane_b32 s65, v96, 16
    v_readlane_b32 s66, v96, 32
    v_readlane_b32 s67, v96, 48
    v_readlane_b32 s68, v100, 0
    v_readlane_b32 s69, v100, 16
    v_lshlrev_b32 v48, 16, v18
    v_and_b32 v49, 0xffff0000, v18
    v_lshlrev_b32 v50, 16, v19
    v_and_b32 v51, 0xffff0000, v19
    v_mul_f32 v106, s60, v102
    v_mul_f32 v110, s62, v102
    v_mul_f32 v114, s64, v102
    v_mul_f32 v118, s66, v102
    v_mul_f32 v122, s68, v102
    s_cbranch_execz L_disp
    v_mul_f32 v104, s61, v102
    v_mul_f32 v108, s63, v102
    v_mul_f32 v112, s65, v102
    v_mul_f32 v116, s67, v102
    v_mul_f32 v120, s69, v102
    v_fma_f32 v104, -v106, v106, v104
    v_fma_f32 v108, -v110, v110, v108
    v_fma_f32 v112, -v114, v114, v112
    v_fma_f32 v116, -v118, v118, v116
    v_fma_f32 v120, -v122, v122, v120
    v_max_f32 v104, 0, v104
    v_max_f32 v108, 0, v108
    v_max_f32 v112, 0, v112
    v_max_f32 v116, 0, v116
    v_max_f32 v120, 0, v120
    v_add_f32 v104, 0x3727c5ac, v104
    v_add_f32 v108, 0x3727c5ac, v108
    v_add_f32 v112, 0x3727c5ac, v112
    v_add_f32 v116, 0x3727c5ac, v116
    v_add_f32 v120, 0x3727c5ac, v120
    v_rsq_f32 v104, v104
    v_rsq_f32 v108, v108
    v_rsq_f32 v112, v112
    v_rsq_f32 v116, v116
    v_rsq_f32 v120, v120
    v_lshlrev_b32 v52, 16, v20
    v_and_b32 v53, 0xffff0000, v20
    v_lshlrev_b32 v54, 16, v21
    v_and_b32 v55, 0xffff0000, v21
    v_lshlrev_b32 v56, 16, v22
    v_and_b32 v57, 0xffff0000, v22
    v_lshlrev_b32 v58, 16, v23
    v_and_b32 v59, 0xffff0000, v23
    v_lshlrev_b32 v60, 16, v24
    v_and_b32 v61, 0xffff0000, v24
    v_lshlrev_b32 v62, 16, v25
    v_and_b32 v63, 0xffff0000, v25
    v_lshlrev_b32 v64, 16, v26
    v_and_b32 v65, 0xffff0000, v26
    v_lshlrev_b32 v66, 16, v27
    v_and_b32 v67, 0xffff0000, v27
    v_lshlrev_b32 v68, 16, v28
    v_and_b32 v69, 0xffff0000, v28
    v_lshlrev_b32 v70, 16, v29
    s_cbranch_execz L_disp
    v_and_b32 v71, 0xffff0000, v29
    v_mul_f32 v106, -v106, v104
    v_mul_f32 v110, -v110, v108
    v_mul_f32 v114, -v114, v112
    v_mul_f32 v118, -v118, v116
    v_mul_f32 v122, -v122, v120
    v_pk_fma_f32 v[32:33], v[32:33], v[104:105], v[106:107] op_sel_hi:[1,0,0]
    v_pk_fma_f32 v[34:35], v[34:35], v[104:105], v[106:107] op_sel_hi:[1,0,0]
    v_pk_fma_f32 v[36:37], v[36:37], v[104:105], v[106:107] op_sel_hi:[1,0,0]
    v_pk_fma_f32 v[38:39], v[38:39], v[104:105], v[106:107] op_sel_hi:[1,0,0]
    v_cvt_pk_f16_f32 v72, v32, v33
    v_cvt_pk_f16_f32 v73, v34, v35
    v_cvt_pk_f16_f32 v74, v36, v37
    v_cvt_pk_f16_f32 v75, v38, v39
    ds_write_b128 v124, v[72:75]
    v_pk_fma_f32 v[40:41], v[40:41], v[108:109], v[110:111] op_sel_hi:[1,0,0]
    v_pk_fma_f32 v[42:43], v[42:43], v[108:109], v[110:111] op_sel_hi:[1,0,0]
    v_pk_fma_f32 v[44:45], v[44:45], v[108:109], v[110:111] op_sel_hi:[1,0,0]
    v_pk_fma_f32 v[46:47], v[46:47], v[108:109], v[110:111] op_sel_hi:[1,0,0]
    v_cvt_pk_f16_f32 v76, v40, v41
    v_cvt_pk_f16_f32 v77, v42, v43
    v_cvt_pk_f16_f32 v78, v44, v45
    v_cvt_pk_f16_f32 v79, v46, v47
    ds_write_b128 v125, v[76:79]
    v_pk_fma_f32 v[48:49], v[48:49], v[112:113], v[114:115] op_sel_hi:[1,0,0]
    v_pk_fma_f32 v[50:51], v[50:51], v[112:113], v[114:115] op_sel_hi:[1,0,0]
    v_pk_fma_f32 v[52:53], v[52:53], v[112:113], v[114:115] op_sel_hi:[1,0,0]
    v_pk_fma_f32 v[54:55], v[54:55], v[112:113], v[114:115] op_sel_hi:[1,0,0]
    v_cvt_pk_f16_f32 v80, v48, v49
    v_cvt_pk_f16_f32 v81, v50, v51
    v_cvt_pk_f16_f32 v82, v52, v53
    s_nop 0
    s_cbranch_execz L_disp
    v_cvt_pk_f16_f32 v83, v54, v55
    ds_write_b128 v126, v[80:83]
    v_pk_fma_f32 v[56:57], v[56:57], v[116:117], v[118:119] op_sel_hi:[1,0,0]
    v_pk_fma_f32 v[58:59], v[58:59], v[116:117], v[118:119] op_sel_hi:[1,0,0]
    v_pk_fma_f32 v[60:61], v[60:61], v[116:117], v[118:119] op_sel_hi:[1,0,0]
    v_pk_fma_f32 v[62:63], v[62:63], v[116:117], v[118:119] op_sel_hi:[1,0,0]
    v_cvt_pk_f16_f32 v84, v56, v57
    v_cvt_pk_f16_f32 v85, v58, v59
    v_cvt_pk_f16_f32 v86, v60, v61
    v_cvt_pk_f16_f32 v87, v62, v63
    ds_write_b128 v127, v[84:87]
    v_pk_fma_f32 v[64:65], v[64:65], v[120:121], v[122:123] op_sel_hi:[1,0,0]
    v_pk_fma_f32 v[66:67], v[66:67], v[120:121], v[122:123] op_sel_hi:[1,0,0]
    v_pk_fma_f32 v[68:69], v[68:69], v[120:121], v[122:123] op_sel_hi:[1,0,0]
    v_pk_fma_f32 v[70:71], v[70:71], v[120:121], v[122:123] op_sel_hi:[1,0,0]
    v_cvt_pk_f16_f32 v88, v64, v65
    v_cvt_pk_f16_f32 v89, v66, v67
    v_cvt_pk_f16_f32 v90, v68, v69
    v_cvt_pk_f16_f32 v91, v70, v71
    s_waitcnt lgkmcnt(0)
    s_barrier
    ds_read_b128 v[32:35], v128 offset:0
    ds_read_b128 v[36:39], v129 offset:1024
    ds_read_b128 v[40:43], v130 offset:2048
    ds_read_b128 v[44:47], v131 offset:3072
    s_cmp_lg_u32 s3, 0
    s_cbranch_scc1 L_nohalo
    buffer_store_dwordx4 v[88:91], v133, s[28:31], s23 offen sc1
L_nohalo:
    s_waitcnt lgkmcnt(3)
    buffer_store_dwordx4 v[32:35], v132, s[28:31], s21 offen offset:0 sc1
    s_waitcnt lgkmcnt(2)
    buffer_store_dwordx4 v[36:39], v132, s[28:31], s21 offen offset:2048 sc1
    s_waitcnt lgkmcnt(1)
    buffer_store_dwordx4 v[40:43], v132, s[28:31], s24 offen offset:0 sc1
    s_waitcnt lgkmcnt(0)
    s_nop 0
    s_cbranch_execz L_disp
    buffer_store_dwordx4 v[44:47], v132, s[28:31], s24 offen offset:2048 sc1
    s_nop 1
    s_branch L_p0_join
L_roleT:
    s_cmp_eq_u32 s97, 1
    s_nop 0
    s_cbranch_scc1 L_onlyT
    s_cmp_eq_u32 s97, 0
    s_nop 0
    s_cbranch_scc1 L_ge
    v_lshlrev_b32 v31, 7, v1
    s_lshl_b32 s23, s5, 14
    s_lshl_b32 s22, s3, 12
    s_add_u32 s23, s23, s22
    s_mov_b32 exec_hi, 0
    buffer_load_dword v252, v31, s[40:43], s23 offen
    s_mov_b32 exec_hi, -1
    s_add_u32 s26, s26, 393216
    s_cmp_ge_u32 s26, 1572864
    s_cselect_b32 s23, 1572864, 0
    s_sub_u32 s26, s26, s23
    s_add_u32 m0, s27, 0x6000
    s_add_u32 s23, s26, 0x0
    buffer_load_dwordx4 v3, s[36:39], s23 offen offset:0  lds
    s_add_u32 s23, s26, 0xbc00
    buffer_load_dwordx4 v3, s[36:39], s23 offen offset:1024  lds
    s_add_u32 m0, s27, 0x8000
    s_add_u32 s23, s26, 0x400
    buffer_load_dwordx4 v3, s[36:39], s23 offen offset:0  lds
    s_add_u32 s23, s26, 0xc000
    buffer_load_dwordx4 v3, s[36:39], s23 offen offset:1024  lds
    s_add_u32 m0, s27, 0xa000
    s_add_u32 s23, s26, 0x800
    buffer_load_dwordx4 v3, s[36:39], s23 offen offset:0  lds
    s_add_u32 s23, s26, 0xc400
    buffer_load_dwordx4 v3, s[36:39], s23 offen offset:1024  lds
    s_add_u32 s26, s26, 393216
    s_cmp_ge_u32 s26, 1572864
    s_cselect_b32 s23, 1572864, 0
    s_sub_u32 s26, s26, s23
    s_add_u32 m0, s27, 0xc000
    s_cbranch_execz L_disp
    s_add_u32 s23, s26, 0x0
    buffer_load_dwordx4 v3, s[36:39], s23 offen offset:0  lds
    s_add_u32 s23, s26, 0xbc00
    buffer_load_dwordx4 v3, s[36:39], s23 offen offset:1024  lds
    s_add_u32 m0, s27, 0xe000
    s_add_u32 s23, s26, 0x400
    buffer_load_dwordx4 v3, s[36:39], s23 offen offset:0  lds
    s_add_u32 s23, s26, 0xc000
    buffer_load_dwordx4 v3, s[36:39], s23 offen offset:1024  lds
    s_add_u32 m0, s27, 0x10000
    s_add_u32 s23, s26, 0x800
    buffer_load_dwordx4 v3, s[36:39], s23 offen offset:0  lds
    s_add_u32 s23, s26, 0xc400
    buffer_load_dwordx4 v3, s[36:39], s23 offen offset:1024  lds
    s_waitcnt vmcnt(21)
    v_readfirstlane_b32 s6, v5
    s_nop 0
    s_mul_i32 s6, s6, 0x9E3779B1
    s_add_u32 s6, s6, 0x7F4A7C15
    v_mov_b32 v254, s6
    v_lshlrev_b32 v32, 16, v10
    v_and_b32 v33, 0xffff0000, v10
    v_lshlrev_b32 v34, 16, v11
    v_and_b32 v35, 0xffff0000, v11
    v_lshlrev_b32 v36, 16, v12
    v_and_b32 v37, 0xffff0000, v12
    v_lshlrev_b32 v38, 16, v13
    v_and_b32 v39, 0xffff0000, v13
    v_mul_f32 v40, 0xbfb8aa3b, v32
    v_mul_f32 v41, 0xbfb8aa3b, v33
    v_mul_f32 v42, 0xbfb8aa3b, v34
    v_mul_f32 v43, 0xbfb8aa3b, v35
    v_mul_f32 v44, 0xbfb8aa3b, v36
    v_mul_f32 v45, 0xbfb8aa3b, v37
    v_mul_f32 v46, 0xbfb8aa3b, v38
    v_mul_f32 v47, 0xbfb8aa3b, v39
    s_cbranch_execz L_disp
    v_exp_f32 v40, v40
    v_exp_f32 v41, v41
    v_exp_f32 v42, v42
    v_exp_f32 v43, v43
    v_exp_f32 v44, v44
    v_exp_f32 v45, v45
    v_exp_f32 v46, v46
    v_exp_f32 v47, v47
    v_add_f32 v40, 1.0, v40
    v_add_f32 v41, 1.0, v41
    v_add_f32 v42, 1.0, v42
    v_add_f32 v43, 1.0, v43
    v_add_f32 v44, 1.0, v44
    v_add_f32 v45, 1.0, v45
    v_add_f32 v46, 1.0, v46
    v_add_f32 v47, 1.0, v47
    v_rcp_f32 v40, v40
    v_rcp_f32 v41, v41
    v_rcp_f32 v42, v42
    v_rcp_f32 v43, v43
    v_rcp_f32 v44, v44
    v_rcp_f32 v45, v45
    v_rcp_f32 v46, v46
    v_rcp_f32 v47, v47
    v_mul_f32 v32, v32, v40
    v_mul_f32 v33, v33, v41
    v_mul_f32 v34, v34, v42
    v_mul_f32 v35, v35, v43
    v_mul_f32 v36, v36, v44
    v_mul_f32 v37, v37, v45
    v_mul_f32 v38, v38, v46
    v_mul_f32 v39, v39, v47
    v_cvt_pk_bf16_f32 v32, v32, v32
    v_lshlrev_b32 v32, 16, v32
    v_cvt_pk_bf16_f32 v33, v33, v33
    v_lshlrev_b32 v33, 16, v33
    v_cvt_pk_bf16_f32 v34, v34, v34
    v_lshlrev_b32 v34, 16, v34
    v_cvt_pk_bf16_f32 v35, v35, v35
    v_lshlrev_b32 v35, 16, v35
    v_cvt_pk_bf16_f32 v36, v36, v36
    v_lshlrev_b32 v36, 16, v36
    v_cvt_pk_bf16_f32 v37, v37, v37
    v_lshlrev_b32 v37, 16, v37
    v_cvt_pk_bf16_f32 v38, v38, v38
    v_lshlrev_b32 v38, 16, v38
    v_cvt_pk_bf16_f32 v39, v39, v39
    v_lshlrev_b32 v39, 16, v39
    v_lshrrev_b32 v40, 16, v32
    v_lshrrev_b32 v41, 16, v33
    v_lshrrev_b32 v42, 16, v34
    v_lshrrev_b32 v43, 16, v35
    v_lshrrev_b32 v44, 16, v36
    v_lshrrev_b32 v45, 16, v37
    v_lshrrev_b32 v46, 16, v38
    s_cbranch_execz L_disp
    v_lshrrev_b32 v47, 16, v39
    s_waitcnt vmcnt(20)
    v_dot2_f32_bf16 v48, v64, v40, 0
    v_dot2_f32_bf16 v49, v64, v32, 0
    v_dot2_f32_bf16 v50, v65, v40, 0
    v_dot2_f32_bf16 v51, v65, v32, 0
    v_dot2_f32_bf16 v52, v66, v40, 0
    v_dot2_f32_bf16 v53, v66, v32, 0
    v_dot2_f32_bf16 v54, v67, v40, 0
    v_dot2_f32_bf16 v55, v67, v32, 0
    s_waitcnt vmcnt(19)
    v_dot2c_f32_bf16 v48, v68, v41
    v_dot2c_f32_bf16 v49, v68, v33
    v_dot2c_f32_bf16 v50, v69, v41
    v_dot2c_f32_bf16 v51, v69, v33
    v_dot2c_f32_bf16 v52, v70, v41
    v_dot2c_f32_bf16 v53, v70, v33
    v_dot2c_f32_bf16 v54, v71, v41
    v_dot2c_f32_bf16 v55, v71, v33
    s_waitcnt vmcnt(18)
    v_dot2c_f32_bf16 v48, v72, v42
    v_dot2c_f32_bf16 v49, v72, v34
    v_dot2c_f32_bf16 v50, v73, v42
    v_dot2c_f32_bf16 v51, v73, v34
    v_dot2c_f32_bf16 v52, v74, v42
    v_dot2c_f32_bf16 v53, v74, v34
    v_dot2c_f32_bf16 v54, v75, v42
    v_dot2c_f32_bf16 v55, v75, v34
    s_waitcnt vmcnt(17)
    v_dot2c_f32_bf16 v48, v76, v43
    v_dot2c_f32_bf16 v49, v76, v35
    v_dot2c_f32_bf16 v50, v77, v43
    v_dot2c_f32_bf16 v51, v77, v35
    v_dot2c_f32_bf16 v52, v78, v43
    v_dot2c_f32_bf16 v53, v78, v35
    v_dot2c_f32_bf16 v54, v79, v43
    v_dot2c_f32_bf16 v55, v79, v35
    s_waitcnt vmcnt(16)
    v_dot2c_f32_bf16 v48, v80, v44
    v_dot2c_f32_bf16 v49, v80, v36
    v_dot2c_f32_bf16 v50, v81, v44
    v_dot2c_f32_bf16 v51, v81, v36
    v_dot2c_f32_bf16 v52, v82, v44
    v_dot2c_f32_bf16 v53, v82, v36
    v_dot2c_f32_bf16 v54, v83, v44
    v_dot2c_f32_bf16 v55, v83, v36
    s_waitcnt vmcnt(15)
    v_dot2c_f32_bf16 v48, v84, v45
    v_dot2c_f32_bf16 v49, v84, v37
    v_dot2c_f32_bf16 v50, v85, v45
    v_dot2c_f32_bf16 v51, v85, v37
    v_dot2c_f32_bf16 v52, v86, v45
    v_dot2c_f32_bf16 v53, v86, v37
    v_dot2c_f32_bf16 v54, v87, v45
    v_dot2c_f32_bf16 v55, v87, v37
    s_cbranch_execz L_disp
    s_waitcnt vmcnt(14)
    v_dot2c_f32_bf16 v48, v88, v46
    v_dot2c_f32_bf16 v49, v88, v38
    v_dot2c_f32_bf16 v50, v89, v46
    v_dot2c_f32_bf16 v51, v89, v38
    v_dot2c_f32_bf16 v52, v90, v46
    v_dot2c_f32_bf16 v53, v90, v38
    v_dot2c_f32_bf16 v54, v91, v46
    v_dot2c_f32_bf16 v55, v91, v38
    s_waitcnt vmcnt(13)
    v_dot2c_f32_bf16 v48, v92, v47
    v_dot2c_f32_bf16 v49, v92, v39
    v_dot2c_f32_bf16 v50, v93, v47
    v_dot2c_f32_bf16 v51, v93, v39
    v_dot2c_f32_bf16 v52, v94, v47
    v_dot2c_f32_bf16 v53, v94, v39
    v_dot2c_f32_bf16 v54, v95, v47
    v_dot2c_f32_bf16 v55, v95, v39
    v_permlane32_swap_b32 v48, v49
    v_permlane32_swap_b32 v50, v51
    v_permlane32_swap_b32 v52, v53
    v_permlane32_swap_b32 v54, v55
    v_add_f32 v48, v48, v49
    v_add_f32 v50, v50, v51
    v_add_f32 v52, v52, v53
    v_add_f32 v54, v54, v55
    v_permlane16_swap_b32 v48, v50
    s_nop 0
    v_permlane16_swap_b32 v52, v54
    v_add_f32 v48, v48, v50
    v_add_f32 v52, v52, v54
    s_nop 0
    v_add_f32_dpp v48, v48, v48 row_ror:4 row_mask:0xf bank_mask:0xf
    v_add_f32_dpp v52, v52, v52 row_ror:4 row_mask:0xf bank_mask:0xf
    s_nop 0
    v_add_f32_dpp v48, v48, v48 row_ror:8 row_mask:0xf bank_mask:0xf
    v_add_f32_dpp v52, v52, v52 row_ror:8 row_mask:0xf bank_mask:0xf
    s_mov_b32 s22, 0x000f000f
    s_mov_b32 s23, 0x000f000f
    s_mov_b64 exec, s[22:23]
    ds_write_b32 v251, v48
    ds_write_b32 v251, v52 offset:16
    s_mov_b64 exec, -1
    s_nop 0
    s_branch L_gj
L_ge:
    s_waitcnt vmcnt(8)
    v_readfirstlane_b32 s6, v5
    s_nop 0
    s_mul_i32 s6, s6, 0x9E3779B1
    s_add_u32 s6, s6, 0x7F4A7C15
    v_mov_b32 v254, s6
    v_lshlrev_b32 v32, 16, v10
    s_nop 0
    s_cbranch_execz L_disp
    v_and_b32 v33, 0xffff0000, v10
    v_lshlrev_b32 v34, 16, v11
    v_and_b32 v35, 0xffff0000, v11
    v_lshlrev_b32 v36, 16, v12
    v_and_b32 v37, 0xffff0000, v12
    v_lshlrev_b32 v38, 16, v13
    v_and_b32 v39, 0xffff0000, v13
    v_mul_f32 v40, 0xbfb8aa3b, v32
    v_mul_f32 v41, 0xbfb8aa3b, v33
    v_mul_f32 v42, 0xbfb8aa3b, v34
    v_mul_f32 v43, 0xbfb8aa3b, v35
    v_mul_f32 v44, 0xbfb8aa3b, v36
    v_mul_f32 v45, 0xbfb8aa3b, v37
    v_mul_f32 v46, 0xbfb8aa3b, v38
    v_mul_f32 v47, 0xbfb8aa3b, v39
    v_exp_f32 v40, v40
    v_exp_f32 v41, v41
    v_exp_f32 v42, v42
    v_exp_f32 v43, v43
    v_exp_f32 v44, v44
    v_exp_f32 v45, v45
    v_exp_f32 v46, v46
    v_exp_f32 v47, v47
    v_add_f32 v40, 1.0, v40
    v_add_f32 v41, 1.0, v41
    v_add_f32 v42, 1.0, v42
    v_add_f32 v43, 1.0, v43
    v_add_f32 v44, 1.0, v44
    v_add_f32 v45, 1.0, v45
    v_add_f32 v46, 1.0, v46
    v_add_f32 v47, 1.0, v47
    v_rcp_f32 v40, v40
    v_rcp_f32 v41, v41
    v_rcp_f32 v42, v42
    v_rcp_f32 v43, v43
    v_rcp_f32 v44, v44
    v_rcp_f32 v45, v45
    v_rcp_f32 v46, v46
    v_rcp_f32 v47, v47
    v_mul_f32 v32, v32, v40
    v_mul_f32 v33, v33, v41
    v_mul_f32 v34, v34, v42
    v_mul_f32 v35, v35, v43
    v_mul_f32 v36, v36, v44
    v_mul_f32 v37, v37, v45
    v_mul_f32 v38, v38, v46
    v_mul_f32 v39, v39, v47
    v_cvt_pk_bf16_f32 v32, v32, v32
    v_lshlrev_b32 v32, 16, v32
    s_nop 0
    s_cbranch_execz L_disp
    v_cvt_pk_bf16_f32 v33, v33, v33
    v_lshlrev_b32 v33, 16, v33
    v_cvt_pk_bf16_f32 v34, v34, v34
    v_lshlrev_b32 v34, 16, v34
    v_cvt_pk_bf16_f32 v35, v35, v35
    v_lshlrev_b32 v35, 16, v35
    v_cvt_pk_bf16_f32 v36, v36, v36
    v_lshlrev_b32 v36, 16, v36
    v_cvt_pk_bf16_f32 v37, v37, v37
    v_lshlrev_b32 v37, 16, v37
    v_cvt_pk_bf16_f32 v38, v38, v38
    v_lshlrev_b32 v38, 16, v38
    v_cvt_pk_bf16_f32 v39, v39, v39
    v_lshlrev_b32 v39, 16, v39
    v_lshrrev_b32 v40, 16, v32
    v_lshrrev_b32 v41, 16, v33
    v_lshrrev_b32 v42, 16, v34
    v_lshrrev_b32 v43, 16, v35
    v_lshrrev_b32 v44, 16, v36
    v_lshrrev_b32 v45, 16, v37
    v_lshrrev_b32 v46, 16, v38
    v_lshrrev_b32 v47, 16, v39
    s_waitcnt vmcnt(7)
    v_dot2_f32_bf16 v48, v64, v40, 0
    v_dot2_f32_bf16 v49, v64, v32, 0
    v_dot2_f32_bf16 v50, v65, v40, 0
    v_dot2_f32_bf16 v51, v65, v32, 0
    v_dot2_f32_bf16 v52, v66, v40, 0
    v_dot2_f32_bf16 v53, v66, v32, 0
    v_dot2_f32_bf16 v54, v67, v40, 0
    v_dot2_f32_bf16 v55, v67, v32, 0
    s_waitcnt vmcnt(6)
    v_dot2c_f32_bf16 v48, v68, v41
    v_dot2c_f32_bf16 v49, v68, v33
    v_dot2c_f32_bf16 v50, v69, v41
    v_dot2c_f32_bf16 v51, v69, v33
    v_dot2c_f32_bf16 v52, v70, v41
    v_dot2c_f32_bf16 v53, v70, v33
    v_dot2c_f32_bf16 v54, v71, v41
    v_dot2c_f32_bf16 v55, v71, v33
    s_waitcnt vmcnt(5)
    v_dot2c_f32_bf16 v48, v72, v42
    v_dot2c_f32_bf16 v49, v72, v34
    v_dot2c_f32_bf16 v50, v73, v42
    v_dot2c_f32_bf16 v51, v73, v34
    v_dot2c_f32_bf16 v52, v74, v42
    v_dot2c_f32_bf16 v53, v74, v34
    v_dot2c_f32_bf16 v54, v75, v42
    s_cbranch_execz L_disp
    v_dot2c_f32_bf16 v55, v75, v34
    s_waitcnt vmcnt(4)
    v_dot2c_f32_bf16 v48, v76, v43
    v_dot2c_f32_bf16 v49, v76, v35
    v_dot2c_f32_bf16 v50, v77, v43
    v_dot2c_f32_bf16 v51, v77, v35
    v_dot2c_f32_bf16 v52, v78, v43
    v_dot2c_f32_bf16 v53, v78, v35
    v_dot2c_f32_bf16 v54, v79, v43
    v_dot2c_f32_bf16 v55, v79, v35
    s_waitcnt vmcnt(3)
    v_dot2c_f32_bf16 v48, v80, v44
    v_dot2c_f32_bf16 v49, v80, v36
    v_dot2c_f32_bf16 v50, v81, v44
    v_dot2c_f32_bf16 v51, v81, v36
    v_dot2c_f32_bf16 v52, v82, v44
    v_dot2c_f32_bf16 v53, v82, v36
    v_dot2c_f32_bf16 v54, v83, v44
    v_dot2c_f32_bf16 v55, v83, v36
    s_waitcnt vmcnt(2)
    v_dot2c_f32_bf16 v48, v84, v45
    v_dot2c_f32_bf16 v49, v84, v37
    v_dot2c_f32_bf16 v50, v85, v45
    v_dot2c_f32_bf16 v51, v85, v37
    v_dot2c_f32_bf16 v52, v86, v45
    v_dot2c_f32_bf16 v53, v86, v37
    v_dot2c_f32_bf16 v54, v87, v45
    v_dot2c_f32_bf16 v55, v87, v37
    s_waitcnt vmcnt(1)
    v_dot2c_f32_bf16 v48, v88, v46
    v_dot2c_f32_bf16 v49, v88, v38
    v_dot2c_f32_bf16 v50, v89, v46
    v_dot2c_f32_bf16 v51, v89, v38
    v_dot2c_f32_bf16 v52, v90, v46
    v_dot2c_f32_bf16 v53, v90, v38
    v_dot2c_f32_bf16 v54, v91, v46
    v_dot2c_f32_bf16 v55, v91, v38
    s_waitcnt vmcnt(0)
    v_dot2c_f32_bf16 v48, v92, v47
    v_dot2c_f32_bf16 v49, v92, v39
    v_dot2c_f32_bf16 v50, v93, v47
    v_dot2c_f32_bf16 v51, v93, v39
    v_dot2c_f32_bf16 v52, v94, v47
    v_dot2c_f32_bf16 v53, v94, v39
    v_dot2c_f32_bf16 v54, v95, v47
    v_dot2c_f32_bf16 v55, v95, v39
    v_permlane32_swap_b32 v48, v49
    v_permlane32_swap_b32 v50, v51
    v_permlane32_swap_b32 v52, v53
    v_permlane32_swap_b32 v54, v55
    v_add_f32 v48, v48, v49
    v_add_f32 v50, v50, v51
    v_add_f32 v52, v52, v53
    v_add_f32 v54, v54, v55
    v_permlane16_swap_b32 v48, v50
    s_nop 0
    v_permlane16_swap_b32 v52, v54
    v_add_f32 v48, v48, v50
    v_add_f32 v52, v52, v54
    s_nop 0
    v_add_f32_dpp v48, v48, v48 row_ror:4 row_mask:0xf bank_mask:0xf
    s_nop 0
    s_cbranch_execz L_disp
    v_add_f32_dpp v52, v52, v52 row_ror:4 row_mask:0xf bank_mask:0xf
    s_nop 0
    v_add_f32_dpp v48, v48, v48 row_ror:8 row_mask:0xf bank_mask:0xf
    v_add_f32_dpp v52, v52, v52 row_ror:8 row_mask:0xf bank_mask:0xf
    s_mov_b32 s22, 0x000f000f
    s_mov_b32 s23, 0x000f000f
    s_mov_b64 exec, s[22:23]
    ds_write_b32 v251, v48
    ds_write_b32 v251, v52 offset:16
    s_mov_b64 exec, -1
L_gj:
    s_waitcnt lgkmcnt(0)
    s_barrier
    s_cmp_lg_u32 s3, 1
    s_nop 0
    s_cbranch_scc1 L_t_nofin
    v_add_u32 v36, 0x1c000, v250
    ds_read_b32 v32, v36 offset:0
    ds_read_b32 v33, v36 offset:128
    ds_read_b32 v34, v36 offset:256
    ds_read_b32 v35, v36 offset:384
    s_lshr_b32 s22, s98, 4
    s_cmp_eq_u32 s22, 1
    s_cselect_b32 s23, 1.0, 0
    s_cmp_eq_u32 s22, 4
    s_cselect_b32 s22, 1.0, s23
    s_waitcnt lgkmcnt(0)
    v_add_f32 v32, v32, v33
    v_add_f32 v34, v34, v35
    v_add_f32 v32, v32, v34
    v_cvt_pk_bf16_f32 v32, v32, v32
    v_lshlrev_b32 v32, 16, v32
    v_add_f32 v32, s22, v32
    v_cvt_pk_bf16_f32 v32, v32, v32
    v_lshlrev_b32 v32, 16, v32
    s_cmp_lg_u32 s97, 0
    s_nop 3
    s_cbranch_scc1 L_t_late
    v_cvt_f16_f32 v33, v32
    s_lshl_b32 s20, s98, 7
    s_add_u32 s20, s20, 0x14000
    v_mov_b32_dpp v34, v33 quad_perm:[1,0,3,2] row_mask:0xf bank_mask:0xf
    v_mov_b32 v32, s6
    v_pack_b32_f16 v33, v33, v34
    s_mov_b64 exec, 0x55555555
    s_nop 0
    s_cbranch_execz L_disp
    buffer_store_dwordx2 v[32:33], v250, s[28:31], s20 offen sc1
    s_mov_b64 exec, -1
    s_nop 1
    s_branch L_t_nofin
L_t_late:
    s_lshl_b32 s20, s98, 7
    s_add_u32 s20, s20, 0x1b000
    s_lshl_b32 s21, s98, 6
    s_add_u32 s21, s21, 0x1d800
    v_lshrrev_b32 v33, 1, v250
    s_mov_b32 exec_hi, 0
    buffer_store_dword v32, v250, s[28:31], s20 offen sc1
    buffer_store_short_d16_hi v32, v33, s[28:31], s21 offen sc1
    s_mov_b32 exec_hi, -1
    s_lshl_b32 s0, s98, 2
    s_add_u32 s0, s0, 0x11f80
    s_nop 0
    s_branch L_t_nofin
L_onlyT:
    s_waitcnt vmcnt(6)
    v_readfirstlane_b32 s6, v5
    s_nop 0
    s_mul_i32 s6, s6, 0x9E3779B1
    s_add_u32 s6, s6, 0x7F4A7C15
    v_mov_b32 v254, s6
L_t_nofin:
    s_cmp_lg_u32 s97, 0
    s_nop 3
    s_cbranch_scc1 L_p0_join
    s_add_u32 m0, s27, 0x0
    s_add_u32 s23, s26, 0x0
    buffer_load_dwordx4 v3, s[36:39], s23 offen offset:0  lds
    s_add_u32 s23, s26, 0xbc00
    buffer_load_dwordx4 v3, s[36:39], s23 offen offset:1024  lds
    s_add_u32 m0, s27, 0x2000
    s_add_u32 s23, s26, 0x400
    buffer_load_dwordx4 v3, s[36:39], s23 offen offset:0  lds
    s_add_u32 s23, s26, 0xc000
    buffer_load_dwordx4 v3, s[36:39], s23 offen offset:1024  lds
    s_add_u32 m0, s27, 0x4000
    s_add_u32 s23, s26, 0x800
    buffer_load_dwordx4 v3, s[36:39], s23 offen offset:0  lds
    s_add_u32 s23, s26, 0xc400
    buffer_load_dwordx4 v3, s[36:39], s23 offen offset:1024  lds
L_p0_join:
    s_mov_b32 s60, 0xffffffff
    s_cbranch_execz L_disp
    s_mov_b32 s61, 0xfffffff0
    s_mov_b32 s62, 0xfffffffe
    s_mov_b32 s63, 0xffffffe0
    s_mov_b32 s64, 0xfffffffc
    s_mov_b32 s65, 0xffffffc0
    s_mov_b32 s66, 0xfffffff8
    s_mov_b32 s67, 0xffffff80
    s_mov_b32 s68, 0xffffff00
    s_mov_b32 s69, 0xfffff000
    s_mov_b32 s70, 0xfffffe00
    s_mov_b32 s71, 0xffffe000
    s_mov_b32 s72, 0xfffffc00
    s_mov_b32 s73, 0xffffc000
    s_mov_b32 s74, 0xfffff800
    s_mov_b32 s75, 0xffff8000
    s_mov_b32 s76, 0xffff0000
    s_mov_b32 s77, 0xfff00000
    s_mov_b32 s78, 0xfffe0000
    s_mov_b32 s79, 0xffe00000
    s_mov_b32 s80, 0xfffc0000
    s_mov_b32 s81, 0xffc00000
    s_mov_b32 s82, 0xfff80000
    s_mov_b32 s83, 0xff800000
    s_mov_b32 s84, 0xff000000
    s_mov_b32 s85, 0xf0000000
    s_mov_b32 s86, 0xfe000000
    s_mov_b32 s87, 0xe0000000
    s_mov_b32 s88, 0xfc000000
    s_mov_b32 s89, 0xc0000000
    s_mov_b32 s90, 0xf8000000
    s_mov_b32 s91, 0x80000000
    s_lshr_b32 s21, s3, 1
    s_or_b32 s21, s21, s4
    s_or_b32 s21, s21, s7
    s_cmp_eq_u32 s21, 0
    s_cselect_b32 s24, -1, 0
    s_mov_b32 s25, s24
    s_cbranch_execz L_disp
    v_lshrrev_b32 v12, 5, v1
    v_lshlrev_b32 v13, 5, v12
    v_and_b32 v14, 31, v1
    v_lshlrev_b32 v15, 2, v12
    v_sub_u32 v14, v14, v15
    v_add_u32 v14, 8, v14
    v_subrev_u32 v208, 0, v14
    v_subrev_u32 v209, 1, v14
    v_subrev_u32 v210, 2, v14
    v_subrev_u32 v211, 3, v14
    v_lshrrev_b32 v208, 3, v208
    v_lshrrev_b32 v209, 3, v209
    v_lshrrev_b32 v210, 3, v210
    v_lshrrev_b32 v211, 3, v211
    v_mov_b32 v212, 0xffff
    v_mov_b32 v213, 0xffff0000
    v_cmp_eq_u32 vcc, 0, v208
    s_nop 1
    v_cndmask_b32 v214, 0, v212, vcc
    v_cmp_eq_u32 vcc, 0, v209
    s_nop 1
    v_cndmask_b32 v215, 0, v213, vcc
    v_or_b32 v240, v214, v215
    v_cmp_eq_u32 vcc, 0, v210
    s_nop 1
    v_cndmask_b32 v214, 0, v212, vcc
    v_cmp_eq_u32 vcc, 0, v211
    s_nop 1
    v_cndmask_b32 v215, 0, v213, vcc
    v_or_b32 v241, v214, v215
    v_cmp_eq_u32 vcc, 1, v208
    s_nop 1
    v_cndmask_b32 v214, 0, v212, vcc
    v_cmp_eq_u32 vcc, 1, v209
    s_nop 1
    v_cndmask_b32 v215, 0, v213, vcc
    v_or_b32 v242, v214, v215
    v_cmp_eq_u32 vcc, 1, v210
    s_nop 1
    v_cndmask_b32 v214, 0, v212, vcc
    v_cmp_eq_u32 vcc, 1, v211
    s_nop 1
    v_cndmask_b32 v215, 0, v213, vcc
    v_or_b32 v243, v214, v215
    v_cmp_eq_u32 vcc, 2, v208
    s_nop 1
    v_cndmask_b32 v214, 0, v212, vcc
    v_cmp_eq_u32 vcc, 2, v209
    s_nop 1
    v_cndmask_b32 v215, 0, v213, vcc
    v_or_b32 v244, v214, v215
    v_cmp_eq_u32 vcc, 2, v210
    s_nop 1
    v_cndmask_b32 v214, 0, v212, vcc
    v_cmp_eq_u32 vcc, 2, v211
    s_nop 1
    v_cndmask_b32 v215, 0, v213, vcc
    v_or_b32 v245, v214, v215
    v_cmp_eq_u32 vcc, 3, v208
    s_nop 1
    v_cndmask_b32 v214, 0, v212, vcc
    s_cbranch_execz L_disp
    v_cmp_eq_u32 vcc, 3, v209
    s_nop 1
    v_cndmask_b32 v215, 0, v213, vcc
    v_or_b32 v246, v214, v215
    v_cmp_eq_u32 vcc, 3, v210
    s_nop 1
    v_cndmask_b32 v214, 0, v212, vcc
    v_cmp_eq_u32 vcc, 3, v211
    s_nop 1
    v_cndmask_b32 v215, 0, v213, vcc
    v_or_b32 v247, v214, v215
    v_cmp_eq_u32 vcc, 4, v208
    s_nop 1
    v_cndmask_b32 v214, 0, v212, vcc
    v_cmp_eq_u32 vcc, 4, v209
    s_nop 1
    v_cndmask_b32 v215, 0, v213, vcc
    v_or_b32 v248, v214, v215
    v_cmp_eq_u32 vcc, 4, v210
    s_nop 1
    v_cndmask_b32 v214, 0, v212, vcc
    v_cmp_eq_u32 vcc, 4, v211
    s_nop 1
    v_cndmask_b32 v215, 0, v213, vcc
    v_or_b32 v249, v214, v215
    s_mul_i32 s20, s4, 327680
    s_add_u32 s20, s20, 0x100000
    s_lshl_b32 s21, s7, 17
    s_add_u32 s20, s20, s21
    s_lshl_b32 s21, s96, 13
    s_add_u32 s52, s20, s21
    s_add_u32 s21, s21, 4096
    s_and_b32 s21, s21, 0x7fff
    s_add_u32 s53, s20, s21
    s_add_u32 s21, s21, 4096
    s_and_b32 s21, s21, 0x7fff
    s_add_u32 s54, s20, s21
    s_add_u32 s21, s21, 4096
    s_and_b32 s21, s21, 0x7fff
    s_add_u32 s55, s20, s21
    s_add_u32 s21, s21, 4096
    s_and_b32 s21, s21, 0x7fff
    s_add_u32 s56, s20, s21
    s_add_u32 s21, s21, 4096
    s_and_b32 s21, s21, 0x7fff
    s_add_u32 s57, s20, s21
    s_add_u32 s21, s21, 4096
    s_and_b32 s21, s21, 0x7fff
    s_add_u32 s58, s20, s21
    s_cbranch_execz L_disp
    s_add_u32 s21, s21, 4096
    s_and_b32 s21, s21, 0x7fff
    s_add_u32 s59, s20, s21
    s_add_u32 s21, s3, 2
    s_lshl_b32 s21, s21, 15
    v_add_u32 v14, s21, v2
    s_add_u32 s22, s3, 0
    s_and_b32 s22, s22, 3
    s_lshl_b32 s23, s22, 10
    v_add_u32 v4, s23, v253
    v_add_u32 v172, s23, v14
    v_add_u32 v168, 49152, v4
    s_lshl_b32 s23, s22, 6
    s_add_u32 s23, s23, 159744
    v_add_u32 v8, s23, v13
    s_add_u32 s22, s3, 1
    s_and_b32 s22, s22, 3
    s_lshl_b32 s23, s22, 10
    v_add_u32 v5, s23, v253
    v_add_u32 v173, s23, v14
    v_add_u32 v169, 49152, v5
    s_lshl_b32 s23, s22, 6
    s_add_u32 s23, s23, 159744
    v_add_u32 v9, s23, v13
    s_add_u32 s22, s3, 2
    s_and_b32 s22, s22, 3
    s_lshl_b32 s23, s22, 10
    v_add_u32 v6, s23, v253
    v_add_u32 v174, s23, v14
    v_add_u32 v170, 49152, v6
    s_lshl_b32 s23, s22, 6
    s_add_u32 s23, s23, 159744
    v_add_u32 v10, s23, v13
    s_add_u32 s22, s3, 3
    s_and_b32 s22, s22, 3
    s_lshl_b32 s23, s22, 10
    v_add_u32 v7, s23, v253
    v_add_u32 v175, s23, v14
    v_add_u32 v171, 49152, v7
    s_lshl_b32 s23, s22, 6
    s_add_u32 s23, s23, 159744
    v_add_u32 v11, s23, v13
    s_lshl_b32 s22, s3, 10
    v_bfe_u32 v184, v1, 3, 1
    v_xor_b32 v184, 1, v184
    v_lshlrev_b32 v184, 15, v184
    v_and_b32 v14, 0x27, v1
    v_add_u32 v14, 24, v14
    v_lshl_add_u32 v184, v14, 4, v184
    v_add_u32 v184, s22, v184
    v_lshrrev_b32 v13, 2, v1
    s_cbranch_execz L_disp
    v_and_b32 v15, 3, v1
    v_lshlrev_b32 v15, 4, v15
    v_lshl_add_u32 v13, v13, 10, v15
    s_and_b32 s21, s3, 1
    s_lshl_b32 s21, s21, 10
    s_lshl_b32 s22, s96, 9
    s_sub_u32 s21, s21, s22
    v_lshrrev_b32 v15, 1, v1
    v_lshlrev_b32 v15, 5, v15
    v_add_u32 v15, s21, v15
    v_and_b32 v15, 0x7ff, v15
    s_cmp_lt_u32 s3, 2
    s_cselect_b32 s22, 16, 0
    s_add_u32 s21, s22, 159744
    v_and_b32 v14, 1, v1
    v_lshl_add_u32 v15, v14, 3, v15
    v_add_u32 v15, s21, v15
    s_lshl_b32 s97, s3, 10
    s_add_u32 s97, s97, 0x14000
    v_lshlrev_b32 v14, 2, v1
    s_lshl_b32 s21, s4, 8
    s_add_u32 s21, s21, 0x1000
    s_and_b32 s22, s5, 7
    s_cmp_eq_u32 s22, 2
    s_cbranch_scc1 L_nosig0
    s_waitcnt vmcnt(0)
    s_cmp_eq_u32 s1, 0
    s_cbranch_scc1 L_nosig0
    s_mov_b64 exec, 1
    buffer_store_dword v254, off, s[28:31], s1
    s_add_u32 s1, s1, 0x8000
    buffer_store_dword v254, off, s[28:31], s1 sc1
    s_mov_b64 exec, -1
    s_barrier
    s_add_u32 m0, s27, 0x0
    s_add_u32 s23, s26, 0x0
    buffer_load_dwordx4 v3, s[36:39], s23 offen offset:0  lds
    s_add_u32 s23, s26, 0xbc00
    buffer_load_dwordx4 v3, s[36:39], s23 offen offset:1024  lds
    s_add_u32 m0, s27, 0x2000
    s_add_u32 s23, s26, 0x400
    buffer_load_dwordx4 v3, s[36:39], s23 offen offset:0  lds
    s_add_u32 s23, s26, 0xc000
    buffer_load_dwordx4 v3, s[36:39], s23 offen offset:1024  lds
    s_add_u32 m0, s27, 0x4000
    s_cbranch_execz L_disp
    s_add_u32 s23, s26, 0x800
    buffer_load_dwordx4 v3, s[36:39], s23 offen offset:0  lds
    s_add_u32 s23, s26, 0xc400
    buffer_load_dwordx4 v3, s[36:39], s23 offen offset:1024  lds
L_nosig0:
    s_and_b32 s22, s5, 6
    s_cmp_eq_u32 s22, 6
    s_cbranch_scc1 L_gl_skip
    v_lshlrev_b32 v31, 7, v1
    s_lshl_b32 s23, s5, 14
    s_lshl_b32 s22, s3, 12
    s_add_u32 s23, s23, s22
    s_mov_b32 exec_hi, 0
    buffer_load_dword v252, v31, s[40:43], s23 offen
    s_mov_b32 exec_hi, -1
    s_add_u32 s26, s26, 393216
    s_cmp_ge_u32 s26, 1572864
    s_cselect_b32 s23, 1572864, 0
    s_sub_u32 s26, s26, s23
    s_add_u32 m0, s27, 0x6000
    s_add_u32 s23, s26, 0x0
    buffer_load_dwordx4 v3, s[36:39], s23 offen offset:0  lds
    s_add_u32 s23, s26, 0xbc00
    buffer_load_dwordx4 v3, s[36:39], s23 offen offset:1024  lds
    s_add_u32 m0, s27, 0x8000
    s_add_u32 s23, s26, 0x400
    buffer_load_dwordx4 v3, s[36:39], s23 offen offset:0  lds
    s_add_u32 s23, s26, 0xc000
    buffer_load_dwordx4 v3, s[36:39], s23 offen offset:1024  lds
    s_add_u32 m0, s27, 0xa000
    s_add_u32 s23, s26, 0x800
    buffer_load_dwordx4 v3, s[36:39], s23 offen offset:0  lds
    s_add_u32 s23, s26, 0xc400
    buffer_load_dwordx4 v3, s[36:39], s23 offen offset:1024  lds
    s_add_u32 s26, s26, 393216
    s_cmp_ge_u32 s26, 1572864
    s_cselect_b32 s23, 1572864, 0
    s_sub_u32 s26, s26, s23
    s_nop 0
    s_cbranch_execz L_disp
    s_add_u32 m0, s27, 0xc000
    s_add_u32 s23, s26, 0x0
    buffer_load_dwordx4 v3, s[36:39], s23 offen offset:0  lds
    s_add_u32 s23, s26, 0xbc00
    buffer_load_dwordx4 v3, s[36:39], s23 offen offset:1024  lds
    s_add_u32 m0, s27, 0xe000
    s_add_u32 s23, s26, 0x400
    buffer_load_dwordx4 v3, s[36:39], s23 offen offset:0  lds
    s_add_u32 s23, s26, 0xc000
    buffer_load_dwordx4 v3, s[36:39], s23 offen offset:1024  lds
    s_add_u32 m0, s27, 0x10000
    s_add_u32 s23, s26, 0x800
    buffer_load_dwordx4 v3, s[36:39], s23 offen offset:0  lds
    s_add_u32 s23, s26, 0xc400
    buffer_load_dwordx4 v3, s[36:39], s23 offen offset:1024  lds
L_gl_skip:
    buffer_load_dwordx4 v[232:235], v2, s[28:31], s97 offen sc1
    s_mov_b32 s17, 0
    s_add_u32 s18, s21, 0x8000
    s_cmp_eq_u32 s16, 0
    s_nop 0
    s_cbranch_scc1 ps_2
pf_1:
    buffer_load_dword v30, v14, s[28:31], s21 offen sc1
    s_add_u32 s17, s17, 1
    s_waitcnt vmcnt(0)
    v_cmp_ne_u32 vcc, s6, v30
    s_nop 4
    s_cbranch_vccz pd_3
    s_cmp_lt_u32 s17, s16
    s_cbranch_scc1 pf_1
ps_2:
    buffer_load_dword v30, v14, s[28:31], s21 offen sc1
    buffer_load_dword v31, v14, s[28:31], s18 offen sc1
    s_add_u32 s17, s17, 1
    s_waitcnt vmcnt(0)
    v_cmp_ne_u32 s[22:23], s6, v30
    v_cmp_ne_u32 vcc, s6, v31
    s_nop 4
    s_and_b64 vcc, vcc, s[22:23]
    s_cmp_lg_u64 s[22:23], 0
    s_cselect_b32 s19, 0, s16
    s_cmp_eq_u64 vcc, 0
    s_cselect_b32 s16, s19, s16
    s_cbranch_scc1 pd_3
    s_nop 0
    s_cbranch_execz L_disp
    s_cmp_lt_u32 s17, 30000
    s_cbranch_scc1 ps_2
pd_3:
    s_mov_b64 exec, -1
    s_cmp_eq_u32 s0, 0
    s_cbranch_scc1 L_nofg
    s_mov_b64 exec, 1
    buffer_store_dword v254, off, s[28:31], s0 sc1
    s_mov_b64 exec, -1
L_nofg:
    buffer_load_dwordx4 v[64:67], v172, s[28:31], s52 offen sc1
    buffer_load_dwordx4 v[68:71], v184, s[28:31], s52 offen sc1
    buffer_load_dwordx4 v[72:75], v173, s[28:31], s52 offen sc1
    buffer_load_dwordx4 v[76:79], v174, s[28:31], s52 offen sc1
    buffer_load_dwordx4 v[80:83], v175, s[28:31], s52 offen sc1
    buffer_load_dwordx4 v[84:87], v172, s[28:31], s53 offen sc1
    buffer_load_dwordx4 v[88:91], v184, s[28:31], s53 offen sc1
    buffer_load_dwordx4 v[92:95], v173, s[28:31], s53 offen sc1
    buffer_load_dwordx4 v[96:99], v174, s[28:31], s53 offen sc1
    buffer_load_dwordx4 v[100:103], v175, s[28:31], s53 offen sc1
    s_mov_b32 s17, 0
cs_4:
    v_xor_b32 v232, s6, v232
    v_xor_b32 v234, s6, v234
    v_or_b32 v232, v232, v234
    v_cmp_ne_u32 vcc, 0, v232
    s_nop 4
    s_cbranch_vccz csd_5
    buffer_load_dwordx4 v[232:235], v2, s[28:31], s97 offen sc1
    s_add_u32 s17, s17, 1
    s_waitcnt vmcnt(0)
    s_cmp_lt_u32 s17, 30000
    s_cbranch_scc1 cs_4
csd_5:
    v_mov_b32 v234, v233
    ds_write_b64 v15, v[234:235]
    s_add_u32 s26, s26, 393216
    s_cmp_ge_u32 s26, 1572864
    s_cselect_b32 s23, 1572864, 0
    s_sub_u32 s26, s26, s23
    s_add_u32 m0, s27, 0x12000
    s_add_u32 s23, s26, 0x0
    buffer_load_dwordx4 v3, s[36:39], s23 offen offset:0  lds
    s_add_u32 s23, s26, 0xbc00
    buffer_load_dwordx4 v3, s[36:39], s23 offen offset:1024  lds
    s_cbranch_execz L_disp
    s_add_u32 m0, s27, 0x14000
    s_add_u32 s23, s26, 0x400
    buffer_load_dwordx4 v3, s[36:39], s23 offen offset:0  lds
    s_add_u32 s23, s26, 0xc000
    buffer_load_dwordx4 v3, s[36:39], s23 offen offset:1024  lds
    s_add_u32 m0, s27, 0x16000
    s_add_u32 s23, s26, 0x800
    buffer_load_dwordx4 v3, s[36:39], s23 offen offset:0  lds
    s_add_u32 s23, s26, 0xc400
    buffer_load_dwordx4 v3, s[36:39], s23 offen offset:1024  lds
    s_waitcnt lgkmcnt(0)
    s_barrier
    ds_read_b128 v[160:163], v8 offset:0
    ds_read_b128 v[164:167], v8 offset:16
    ds_read_b128 v[176:179], v9 offset:0
    ds_read_b128 v[180:183], v9 offset:16
    ds_read_b64_tr_b16 a[0:1], v4 offset:0
    ds_read_b64_tr_b16 a[2:3], v4 offset:256
    ds_read_b64_tr_b16 a[4:5], v4 offset:8192
    ds_read_b64_tr_b16 a[6:7], v4 offset:8448
    ds_read_b64_tr_b16 a[8:9], v4 offset:16384
    ds_read_b64_tr_b16 a[10:11], v4 offset:16640
    ds_read_b128 v[192:195], v10 offset:0
    ds_read_b128 v[196:199], v10 offset:16
    ds_read_b64_tr_b16 a[12:13], v5 offset:0
    ds_read_b64_tr_b16 a[14:15], v5 offset:256
    ds_read_b64_tr_b16 a[16:17], v5 offset:8192
    ds_read_b64_tr_b16 a[18:19], v5 offset:8448
    ds_read_b64_tr_b16 a[20:21], v5 offset:16384
    ds_read_b64_tr_b16 a[22:23], v5 offset:16640
    s_waitcnt vmcnt(15)
    v_fma_mix_f32 v208, v64, v160, v164 op_sel:[0,0,0] op_sel_hi:[1,1,1]
    v_fma_mix_f32 v209, v64, v160, v164 op_sel:[1,1,1] op_sel_hi:[1,1,1]
    s_cbranch_execz L_disp
    v_fma_mix_f32 v210, v65, v161, v165 op_sel:[0,0,0] op_sel_hi:[1,1,1]
    v_fma_mix_f32 v211, v65, v161, v165 op_sel:[1,1,1] op_sel_hi:[1,1,1]
    v_fma_mix_f32 v212, v66, v162, v166 op_sel:[0,0,0] op_sel_hi:[1,1,1]
    v_fma_mix_f32 v213, v66, v162, v166 op_sel:[1,1,1] op_sel_hi:[1,1,1]
    v_fma_mix_f32 v214, v67, v163, v167 op_sel:[0,0,0] op_sel_hi:[1,1,1]
    v_fma_mix_f32 v215, v67, v163, v167 op_sel:[1,1,1] op_sel_hi:[1,1,1]
    v_cvt_pk_bf16_f32 v216, v208, v209
    v_cvt_pk_bf16_f32 v217, v210, v211
    v_cvt_pk_bf16_f32 v218, v212, v213
    v_cvt_pk_bf16_f32 v219, v214, v215
    s_waitcnt vmcnt(14)
    v_fma_mix_f32 v208, v68, v160, v164 op_sel:[0,0,0] op_sel_hi:[1,1,1]
    v_fma_mix_f32 v209, v68, v160, v164 op_sel:[1,1,1] op_sel_hi:[1,1,1]
    v_fma_mix_f32 v210, v69, v161, v165 op_sel:[0,0,0] op_sel_hi:[1,1,1]
    v_fma_mix_f32 v211, v69, v161, v165 op_sel:[1,1,1] op_sel_hi:[1,1,1]
    v_fma_mix_f32 v212, v70, v162, v166 op_sel:[0,0,0] op_sel_hi:[1,1,1]
    v_fma_mix_f32 v213, v70, v162, v166 op_sel:[1,1,1] op_sel_hi:[1,1,1]
    v_fma_mix_f32 v214, v71, v163, v167 op_sel:[0,0,0] op_sel_hi:[1,1,1]
    v_fma_mix_f32 v215, v71, v163, v167 op_sel:[1,1,1] op_sel_hi:[1,1,1]
    v_cvt_pk_bf16_f32 v228, v208, v209
    v_cvt_pk_bf16_f32 v229, v210, v211
    v_cvt_pk_bf16_f32 v230, v212, v213
    v_cvt_pk_bf16_f32 v231, v214, v215
    ds_read_b128 v[160:163], v11 offset:0
    ds_read_b128 v[164:167], v11 offset:16
    s_waitcnt vmcnt(13)
    v_fma_mix_f32 v208, v72, v176, v180 op_sel:[0,0,0] op_sel_hi:[1,1,1]
    v_fma_mix_f32 v209, v72, v176, v180 op_sel:[1,1,1] op_sel_hi:[1,1,1]
    v_fma_mix_f32 v210, v73, v177, v181 op_sel:[0,0,0] op_sel_hi:[1,1,1]
    v_fma_mix_f32 v211, v73, v177, v181 op_sel:[1,1,1] op_sel_hi:[1,1,1]
    v_fma_mix_f32 v212, v74, v178, v182 op_sel:[0,0,0] op_sel_hi:[1,1,1]
    v_fma_mix_f32 v213, v74, v178, v182 op_sel:[1,1,1] op_sel_hi:[1,1,1]
    s_nop 0
    s_cbranch_execz L_disp
    v_fma_mix_f32 v214, v75, v179, v183 op_sel:[0,0,0] op_sel_hi:[1,1,1]
    v_fma_mix_f32 v215, v75, v179, v183 op_sel:[1,1,1] op_sel_hi:[1,1,1]
    v_cvt_pk_bf16_f32 v220, v208, v209
    v_cvt_pk_bf16_f32 v221, v210, v211
    v_cvt_pk_bf16_f32 v222, v212, v213
    v_cvt_pk_bf16_f32 v223, v214, v215
    s_waitcnt lgkmcnt(2)
    v_mfma_f32_32x32x16_bf16 v[16:31], a[0:3], v[216:219], 0
    buffer_load_dwordx4 v[104:107], v172, s[28:31], s54 offen sc1
    buffer_load_dwordx4 v[108:111], v184, s[28:31], s54 offen sc1
    buffer_load_dwordx4 v[112:115], v173, s[28:31], s54 offen sc1
    ds_read_b64_tr_b16 a[24:25], v6 offset:0
    s_waitcnt vmcnt(15)
    v_fma_mix_f32 v208, v76, v192, v196 op_sel:[0,0,0] op_sel_hi:[1,1,1]
    v_mfma_f32_32x32x16_bf16 v[32:47], a[4:7], v[216:219], 0
    ds_read_b64_tr_b16 a[26:27], v6 offset:256
    ds_read_b64_tr_b16 a[28:29], v6 offset:8192
    v_fma_mix_f32 v209, v76, v192, v196 op_sel:[1,1,1] op_sel_hi:[1,1,1]
    v_fma_mix_f32 v210, v77, v193, v197 op_sel:[0,0,0] op_sel_hi:[1,1,1]
    v_fma_mix_f32 v211, v77, v193, v197 op_sel:[1,1,1] op_sel_hi:[1,1,1]
    v_mfma_f32_32x32x16_bf16 v[48:63], v[216:219], a[8:11], 0
    ds_read_b64_tr_b16 a[30:31], v6 offset:8448
    v_fma_mix_f32 v212, v78, v194, v198 op_sel:[0,0,0] op_sel_hi:[1,1,1]
    v_fma_mix_f32 v213, v78, v194, v198 op_sel:[1,1,1] op_sel_hi:[1,1,1]
    v_fma_mix_f32 v214, v79, v195, v199 op_sel:[0,0,0] op_sel_hi:[1,1,1]
    v_mfma_f32_32x32x16_bf16 a[64:79], a[4:7], v[228:231], 0
    ds_read_b64_tr_b16 a[32:33], v6 offset:16384
    ds_read_b64_tr_b16 a[34:35], v6 offset:16640
    v_fma_mix_f32 v215, v79, v195, v199 op_sel:[1,1,1] op_sel_hi:[1,1,1]
    v_cvt_pk_bf16_f32 v224, v208, v209
    v_cvt_pk_bf16_f32 v225, v210, v211
    v_mfma_f32_32x32x16_bf16 a[80:95], v[228:231], a[8:11], 0
    s_nop 0
    s_cbranch_execz L_disp
    ds_read_b128 v[176:179], v8 offset:256
    ds_read_b128 v[180:183], v8 offset:272
    v_cvt_pk_bf16_f32 v226, v212, v213
    v_cvt_pk_bf16_f32 v227, v214, v215
    s_waitcnt lgkmcnt(8)
    v_mfma_f32_32x32x16_bf16 v[16:31], a[12:15], v[220:223], v[16:31]
    buffer_load_dwordx4 v[116:119], v174, s[28:31], s54 offen sc1
    buffer_load_dwordx4 v[120:123], v175, s[28:31], s54 offen sc1
    buffer_load_dwordx4 v[124:127], v172, s[28:31], s55 offen sc1
    ds_read_b64_tr_b16 a[0:1], v7 offset:0
    ds_read_b64_tr_b16 a[2:3], v7 offset:256
    s_waitcnt vmcnt(17)
    v_fma_mix_f32 v208, v80, v160, v164 op_sel:[0,0,0] op_sel_hi:[1,1,1]
    v_fma_mix_f32 v209, v80, v160, v164 op_sel:[1,1,1] op_sel_hi:[1,1,1]
    v_fma_mix_f32 v210, v81, v161, v165 op_sel:[0,0,0] op_sel_hi:[1,1,1]
    v_mfma_f32_32x32x16_bf16 v[32:47], a[16:19], v[220:223], v[32:47]
    ds_read_b64_tr_b16 a[4:5], v7 offset:8192
    ds_read_b64_tr_b16 a[6:7], v7 offset:8448
    ds_read_b64_tr_b16 a[8:9], v7 offset:16384
    v_fma_mix_f32 v211, v81, v161, v165 op_sel:[1,1,1] op_sel_hi:[1,1,1]
    v_fma_mix_f32 v212, v82, v162, v166 op_sel:[0,0,0] op_sel_hi:[1,1,1]
    v_fma_mix_f32 v213, v82, v162, v166 op_sel:[1,1,1] op_sel_hi:[1,1,1]
    v_fma_mix_f32 v214, v83, v163, v167 op_sel:[0,0,0] op_sel_hi:[1,1,1]
    v_fma_mix_f32 v215, v83, v163, v167 op_sel:[1,1,1] op_sel_hi:[1,1,1]
    v_mfma_f32_32x32x16_bf16 v[48:63], v[220:223], a[20:23], v[48:63]
    ds_read_b64_tr_b16 a[10:11], v7 offset:16640
    ds_read_b128 v[192:195], v9 offset:256
    ds_read_b128 v[196:199], v9 offset:272
    v_cvt_pk_bf16_f32 v216, v208, v209
    v_cvt_pk_bf16_f32 v217, v210, v211
    v_cvt_pk_bf16_f32 v218, v212, v213
    v_cvt_pk_bf16_f32 v219, v214, v215
    s_waitcnt lgkmcnt(8)
    s_cbranch_execz L_disp
    v_mfma_f32_32x32x16_bf16 v[16:31], a[24:27], v[224:227], v[16:31]
    buffer_load_dwordx4 v[128:131], v184, s[28:31], s55 offen sc1
    buffer_load_dwordx4 v[132:135], v173, s[28:31], s55 offen sc1
    buffer_load_dwordx4 v[136:139], v174, s[28:31], s55 offen sc1
    ds_read_b64_tr_b16 a[12:13], v4 offset:4096
    ds_read_b64_tr_b16 a[14:15], v4 offset:4352
    s_waitcnt vmcnt(19)
    v_fma_mix_f32 v208, v84, v176, v180 op_sel:[0,0,0] op_sel_hi:[1,1,1]
    v_fma_mix_f32 v209, v84, v176, v180 op_sel:[1,1,1] op_sel_hi:[1,1,1]
    v_fma_mix_f32 v210, v85, v177, v181 op_sel:[0,0,0] op_sel_hi:[1,1,1]
    v_fma_mix_f32 v211, v85, v177, v181 op_sel:[1,1,1] op_sel_hi:[1,1,1]
    v_fma_mix_f32 v212, v86, v178, v182 op_sel:[0,0,0] op_sel_hi:[1,1,1]
    v_fma_mix_f32 v213, v86, v178, v182 op_sel:[1,1,1] op_sel_hi:[1,1,1]
    v_fma_mix_f32 v214, v87, v179, v183 op_sel:[0,0,0] op_sel_hi:[1,1,1]
    v_fma_mix_f32 v215, v87, v179, v183 op_sel:[1,1,1] op_sel_hi:[1,1,1]
    v_mfma_f32_32x32x16_bf16 v[32:47], a[28:31], v[224:227], v[32:47]
    ds_read_b64_tr_b16 a[16:17], v4 offset:12288
    ds_read_b64_tr_b16 a[18:19], v4 offset:12544
    ds_read_b64_tr_b16 a[20:21], v4 offset:20480
    v_cvt_pk_bf16_f32 v220, v208, v209
    v_cvt_pk_bf16_f32 v221, v210, v211
    v_cvt_pk_bf16_f32 v222, v212, v213
    v_cvt_pk_bf16_f32 v223, v214, v215
    s_waitcnt vmcnt(18)
    v_fma_mix_f32 v208, v88, v176, v180 op_sel:[0,0,0] op_sel_hi:[1,1,1]
    v_fma_mix_f32 v209, v88, v176, v180 op_sel:[1,1,1] op_sel_hi:[1,1,1]
    v_fma_mix_f32 v210, v89, v177, v181 op_sel:[0,0,0] op_sel_hi:[1,1,1]
    v_mfma_f32_32x32x16_bf16 v[48:63], v[224:227], a[32:35], v[48:63]
    ds_read_b64_tr_b16 a[22:23], v4 offset:20736
    ds_read_b128 v[160:163], v10 offset:256
    ds_read_b128 v[164:167], v10 offset:272
    v_fma_mix_f32 v211, v89, v177, v181 op_sel:[1,1,1] op_sel_hi:[1,1,1]
    s_nop 0
    s_cbranch_execz L_disp
    v_fma_mix_f32 v212, v90, v178, v182 op_sel:[0,0,0] op_sel_hi:[1,1,1]
    v_fma_mix_f32 v213, v90, v178, v182 op_sel:[1,1,1] op_sel_hi:[1,1,1]
    v_fma_mix_f32 v214, v91, v179, v183 op_sel:[0,0,0] op_sel_hi:[1,1,1]
    v_fma_mix_f32 v215, v91, v179, v183 op_sel:[1,1,1] op_sel_hi:[1,1,1]
    v_cvt_pk_bf16_f32 v228, v208, v209
    v_cvt_pk_bf16_f32 v229, v210, v211
    v_cvt_pk_bf16_f32 v230, v212, v213
    v_cvt_pk_bf16_f32 v231, v214, v215
    s_waitcnt lgkmcnt(8)
    v_mfma_f32_32x32x16_bf16 v[16:31], a[0:3], v[216:219], v[16:31]
    buffer_load_dwordx4 v[140:143], v175, s[28:31], s55 offen sc1
    buffer_load_dwordx4 v[144:147], v172, s[28:31], s56 offen sc1
    buffer_load_dwordx4 v[148:151], v184, s[28:31], s56 offen sc1
    ds_read_b64_tr_b16 a[24:25], v5 offset:4096
    ds_read_b64_tr_b16 a[26:27], v5 offset:4352
    s_waitcnt vmcnt(20)
    v_fma_mix_f32 v208, v92, v192, v196 op_sel:[0,0,0] op_sel_hi:[1,1,1]
    v_fma_mix_f32 v209, v92, v192, v196 op_sel:[1,1,1] op_sel_hi:[1,1,1]
    v_fma_mix_f32 v210, v93, v193, v197 op_sel:[0,0,0] op_sel_hi:[1,1,1]
    v_mfma_f32_32x32x16_bf16 v[32:47], a[4:7], v[216:219], v[32:47]
    ds_read_b64_tr_b16 a[28:29], v5 offset:12288
    ds_read_b64_tr_b16 a[30:31], v5 offset:12544
    ds_read_b64_tr_b16 a[32:33], v5 offset:20480
    v_fma_mix_f32 v211, v93, v193, v197 op_sel:[1,1,1] op_sel_hi:[1,1,1]
    v_fma_mix_f32 v212, v94, v194, v198 op_sel:[0,0,0] op_sel_hi:[1,1,1]
    v_fma_mix_f32 v213, v94, v194, v198 op_sel:[1,1,1] op_sel_hi:[1,1,1]
    v_fma_mix_f32 v214, v95, v195, v199 op_sel:[0,0,0] op_sel_hi:[1,1,1]
    v_fma_mix_f32 v215, v95, v195, v199 op_sel:[1,1,1] op_sel_hi:[1,1,1]
    v_mfma_f32_32x32x16_bf16 v[48:63], v[216:219], a[8:11], v[48:63]
    ds_read_b64_tr_b16 a[34:35], v5 offset:20736
    ds_read_b128 v[176:179], v11 offset:256
    ds_read_b128 v[180:183], v11 offset:272
    s_nop 0
    s_cbranch_execz L_disp
    v_cvt_pk_bf16_f32 v224, v208, v209
    v_cvt_pk_bf16_f32 v225, v210, v211
    v_cvt_pk_bf16_f32 v226, v212, v213
    v_cvt_pk_bf16_f32 v227, v214, v215
    s_waitcnt lgkmcnt(8)
    v_mfma_f32_32x32x16_bf16 v[16:31], a[12:15], v[220:223], v[16:31]
    buffer_load_dwordx4 v[152:155], v173, s[28:31], s56 offen sc1
    buffer_load_dwordx4 v[156:159], v174, s[28:31], s56 offen sc1
    buffer_load_dwordx4 v[64:67], v175, s[28:31], s56 offen sc1
    ds_read_b64_tr_b16 a[0:1], v6 offset:4096
    s_waitcnt vmcnt(22)
    v_fma_mix_f32 v208, v96, v160, v164 op_sel:[0,0,0] op_sel_hi:[1,1,1]
    v_mfma_f32_32x32x16_bf16 v[32:47], a[16:19], v[220:223], v[32:47]
    ds_read_b64_tr_b16 a[2:3], v6 offset:4352
    ds_read_b64_tr_b16 a[4:5], v6 offset:12288
    v_fma_mix_f32 v209, v96, v160, v164 op_sel:[1,1,1] op_sel_hi:[1,1,1]
    v_fma_mix_f32 v210, v97, v161, v165 op_sel:[0,0,0] op_sel_hi:[1,1,1]
    v_fma_mix_f32 v211, v97, v161, v165 op_sel:[1,1,1] op_sel_hi:[1,1,1]
    v_mfma_f32_32x32x16_bf16 v[48:63], v[220:223], a[20:23], v[48:63]
    ds_read_b64_tr_b16 a[6:7], v6 offset:12544
    v_fma_mix_f32 v212, v98, v162, v166 op_sel:[0,0,0] op_sel_hi:[1,1,1]
    v_fma_mix_f32 v213, v98, v162, v166 op_sel:[1,1,1] op_sel_hi:[1,1,1]
    v_fma_mix_f32 v214, v99, v163, v167 op_sel:[0,0,0] op_sel_hi:[1,1,1]
    v_mfma_f32_32x32x16_bf16 a[64:79], a[16:19], v[228:231], a[64:79]
    ds_read_b64_tr_b16 a[8:9], v6 offset:20480
    ds_read_b64_tr_b16 a[10:11], v6 offset:20736
    v_fma_mix_f32 v215, v99, v163, v167 op_sel:[1,1,1] op_sel_hi:[1,1,1]
    v_cvt_pk_bf16_f32 v216, v208, v209
    v_cvt_pk_bf16_f32 v217, v210, v211
    v_mfma_f32_32x32x16_bf16 a[80:95], v[228:231], a[20:23], a[80:95]
    ds_read_b128 v[192:195], v8 offset:512
    ds_read_b128 v[196:199], v8 offset:528
    s_nop 0
    s_cbranch_execz L_disp
    v_cvt_pk_bf16_f32 v218, v212, v213
    v_cvt_pk_bf16_f32 v219, v214, v215
    s_waitcnt lgkmcnt(8)
    v_mfma_f32_32x32x16_bf16 v[16:31], a[24:27], v[224:227], v[16:31]
    buffer_load_dwordx4 v[68:71], v172, s[28:31], s57 offen sc1
    buffer_load_dwordx4 v[72:75], v184, s[28:31], s57 offen sc1
    buffer_load_dwordx4 v[76:79], v173, s[28:31], s57 offen sc1
    ds_read_b64_tr_b16 a[12:13], v7 offset:4096
    ds_read_b64_tr_b16 a[14:15], v7 offset:4352
    s_waitcnt vmcnt(24)
    v_fma_mix_f32 v208, v100, v176, v180 op_sel:[0,0,0] op_sel_hi:[1,1,1]
    v_fma_mix_f32 v209, v100, v176, v180 op_sel:[1,1,1] op_sel_hi:[1,1,1]
    v_fma_mix_f32 v210, v101, v177, v181 op_sel:[0,0,0] op_sel_hi:[1,1,1]
    v_mfma_f32_32x32x16_bf16 v[32:47], a[28:31], v[224:227], v[32:47]
    ds_read_b64_tr_b16 a[16:17], v7 offset:12288
    ds_read_b64_tr_b16 a[18:19], v7 offset:12544
    ds_read_b64_tr_b16 a[20:21], v7 offset:20480
    v_fma_mix_f32 v211, v101, v177, v181 op_sel:[1,1,1] op_sel_hi:[1,1,1]
    v_fma_mix_f32 v212, v102, v178, v182 op_sel:[0,0,0] op_sel_hi:[1,1,1]
    v_fma_mix_f32 v213, v102, v178, v182 op_sel:[1,1,1] op_sel_hi:[1,1,1]
    v_fma_mix_f32 v214, v103, v179, v183 op_sel:[0,0,0] op_sel_hi:[1,1,1]
    v_fma_mix_f32 v215, v103, v179, v183 op_sel:[1,1,1] op_sel_hi:[1,1,1]
    v_mfma_f32_32x32x16_bf16 v[48:63], v[224:227], a[32:35], v[48:63]
    ds_read_b64_tr_b16 a[22:23], v7 offset:20736
    ds_read_b128 v[160:163], v9 offset:512
    ds_read_b128 v[164:167], v9 offset:528
    v_cvt_pk_bf16_f32 v220, v208, v209
    v_cvt_pk_bf16_f32 v221, v210, v211
    v_cvt_pk_bf16_f32 v222, v212, v213
    v_cvt_pk_bf16_f32 v223, v214, v215
    s_waitcnt lgkmcnt(8)
    v_mfma_f32_32x32x16_bf16 v[16:31], a[0:3], v[216:219], v[16:31]
    buffer_load_dwordx4 v[80:83], v174, s[28:31], s57 offen sc1
    s_cbranch_execz L_disp
    buffer_load_dwordx4 v[84:87], v175, s[28:31], s57 offen sc1
    buffer_load_dwordx4 v[88:91], v172, s[28:31], s58 offen sc1
    ds_read_b64_tr_b16 a[24:25], v4 offset:24576
    ds_read_b64_tr_b16 a[26:27], v4 offset:24832
    s_waitcnt vmcnt(20)
    v_fma_mix_f32 v208, v104, v192, v196 op_sel:[0,0,0] op_sel_hi:[1,1,1]
    v_fma_mix_f32 v209, v104, v192, v196 op_sel:[1,1,1] op_sel_hi:[1,1,1]
    v_fma_mix_f32 v210, v105, v193, v197 op_sel:[0,0,0] op_sel_hi:[1,1,1]
    v_fma_mix_f32 v211, v105, v193, v197 op_sel:[1,1,1] op_sel_hi:[1,1,1]
    v_fma_mix_f32 v212, v106, v194, v198 op_sel:[0,0,0] op_sel_hi:[1,1,1]
    v_fma_mix_f32 v213, v106, v194, v198 op_sel:[1,1,1] op_sel_hi:[1,1,1]
    v_fma_mix_f32 v214, v107, v195, v199 op_sel:[0,0,0] op_sel_hi:[1,1,1]
    v_fma_mix_f32 v215, v107, v195, v199 op_sel:[1,1,1] op_sel_hi:[1,1,1]
    v_mfma_f32_32x32x16_bf16 v[32:47], a[4:7], v[216:219], v[32:47]
    ds_read_b64_tr_b16 a[28:29], v4 offset:32768
    ds_read_b64_tr_b16 a[30:31], v4 offset:33024
    ds_read_b64_tr_b16 a[32:33], v4 offset:40960
    v_cvt_pk_bf16_f32 v224, v208, v209
    v_cvt_pk_bf16_f32 v225, v210, v211
    v_cvt_pk_bf16_f32 v226, v212, v213
    v_cvt_pk_bf16_f32 v227, v214, v215
    s_waitcnt vmcnt(19)
    v_fma_mix_f32 v208, v108, v192, v196 op_sel:[0,0,0] op_sel_hi:[1,1,1]
    v_fma_mix_f32 v209, v108, v192, v196 op_sel:[1,1,1] op_sel_hi:[1,1,1]
    v_fma_mix_f32 v210, v109, v193, v197 op_sel:[0,0,0] op_sel_hi:[1,1,1]
    v_mfma_f32_32x32x16_bf16 v[48:63], v[216:219], a[8:11], v[48:63]
    ds_read_b64_tr_b16 a[34:35], v4 offset:41216
    ds_read_b128 v[176:179], v10 offset:512
    ds_read_b128 v[180:183], v10 offset:528
    v_fma_mix_f32 v211, v109, v193, v197 op_sel:[1,1,1] op_sel_hi:[1,1,1]
    v_fma_mix_f32 v212, v110, v194, v198 op_sel:[0,0,0] op_sel_hi:[1,1,1]
    v_fma_mix_f32 v213, v110, v194, v198 op_sel:[1,1,1] op_sel_hi:[1,1,1]
    s_nop 0
    s_cbranch_execz L_disp
    v_fma_mix_f32 v214, v111, v195, v199 op_sel:[0,0,0] op_sel_hi:[1,1,1]
    v_fma_mix_f32 v215, v111, v195, v199 op_sel:[1,1,1] op_sel_hi:[1,1,1]
    v_cvt_pk_bf16_f32 v228, v208, v209
    v_cvt_pk_bf16_f32 v229, v210, v211
    v_cvt_pk_bf16_f32 v230, v212, v213
    v_cvt_pk_bf16_f32 v231, v214, v215
    s_waitcnt lgkmcnt(8)
    v_mfma_f32_32x32x16_bf16 v[16:31], a[12:15], v[220:223], v[16:31]
    buffer_load_dwordx4 v[92:95], v184, s[28:31], s58 offen sc1
    buffer_load_dwordx4 v[96:99], v173, s[28:31], s58 offen sc1
    buffer_load_dwordx4 v[100:103], v174, s[28:31], s58 offen sc1
    ds_read_b64_tr_b16 a[0:1], v5 offset:24576
    ds_read_b64_tr_b16 a[2:3], v5 offset:24832
    s_waitcnt vmcnt(21)
    v_fma_mix_f32 v208, v112, v160, v164 op_sel:[0,0,0] op_sel_hi:[1,1,1]
    v_fma_mix_f32 v209, v112, v160, v164 op_sel:[1,1,1] op_sel_hi:[1,1,1]
    v_fma_mix_f32 v210, v113, v161, v165 op_sel:[0,0,0] op_sel_hi:[1,1,1]
    v_mfma_f32_32x32x16_bf16 v[32:47], a[16:19], v[220:223], v[32:47]
    ds_read_b64_tr_b16 a[4:5], v5 offset:32768
    ds_read_b64_tr_b16 a[6:7], v5 offset:33024
    ds_read_b64_tr_b16 a[8:9], v5 offset:40960
    v_fma_mix_f32 v211, v113, v161, v165 op_sel:[1,1,1] op_sel_hi:[1,1,1]
    v_fma_mix_f32 v212, v114, v162, v166 op_sel:[0,0,0] op_sel_hi:[1,1,1]
    v_fma_mix_f32 v213, v114, v162, v166 op_sel:[1,1,1] op_sel_hi:[1,1,1]
    v_fma_mix_f32 v214, v115, v163, v167 op_sel:[0,0,0] op_sel_hi:[1,1,1]
    v_fma_mix_f32 v215, v115, v163, v167 op_sel:[1,1,1] op_sel_hi:[1,1,1]
    v_mfma_f32_32x32x16_bf16 v[48:63], v[220:223], a[20:23], v[48:63]
    ds_read_b64_tr_b16 a[10:11], v5 offset:41216
    ds_read_b128 v[192:195], v11 offset:512
    ds_read_b128 v[196:199], v11 offset:528
    v_cvt_pk_bf16_f32 v216, v208, v209
    v_cvt_pk_bf16_f32 v217, v210, v211
    s_nop 0
    s_cbranch_execz L_disp
    v_cvt_pk_bf16_f32 v218, v212, v213
    v_cvt_pk_bf16_f32 v219, v214, v215
    s_waitcnt lgkmcnt(8)
    v_mfma_f32_32x32x16_bf16 v[16:31], a[24:27], v[224:227], v[16:31]
    buffer_load_dwordx4 v[104:107], v175, s[28:31], s58 offen sc1
    buffer_load_dwordx4 v[108:111], v172, s[28:31], s59 offen sc1
    buffer_load_dwordx4 v[112:115], v184, s[28:31], s59 offen sc1
    ds_read_b64_tr_b16 a[12:13], v6 offset:24576
    s_waitcnt vmcnt(23)
    v_fma_mix_f32 v208, v116, v176, v180 op_sel:[0,0,0] op_sel_hi:[1,1,1]
    v_mfma_f32_32x32x16_bf16 v[32:47], a[28:31], v[224:227], v[32:47]
    ds_read_b64_tr_b16 a[14:15], v6 offset:24832
    ds_read_b64_tr_b16 a[16:17], v6 offset:32768
    v_fma_mix_f32 v209, v116, v176, v180 op_sel:[1,1,1] op_sel_hi:[1,1,1]
    v_fma_mix_f32 v210, v117, v177, v181 op_sel:[0,0,0] op_sel_hi:[1,1,1]
    v_fma_mix_f32 v211, v117, v177, v181 op_sel:[1,1,1] op_sel_hi:[1,1,1]
    v_mfma_f32_32x32x16_bf16 v[48:63], v[224:227], a[32:35], v[48:63]
    ds_read_b64_tr_b16 a[18:19], v6 offset:33024
    v_fma_mix_f32 v212, v118, v178, v182 op_sel:[0,0,0] op_sel_hi:[1,1,1]
    v_fma_mix_f32 v213, v118, v178, v182 op_sel:[1,1,1] op_sel_hi:[1,1,1]
    v_fma_mix_f32 v214, v119, v179, v183 op_sel:[0,0,0] op_sel_hi:[1,1,1]
    v_mfma_f32_32x32x16_bf16 a[64:79], a[28:31], v[228:231], a[64:79]
    ds_read_b64_tr_b16 a[20:21], v6 offset:40960
    ds_read_b64_tr_b16 a[22:23], v6 offset:41216
    v_fma_mix_f32 v215, v119, v179, v183 op_sel:[1,1,1] op_sel_hi:[1,1,1]
    v_cvt_pk_bf16_f32 v220, v208, v209
    v_cvt_pk_bf16_f32 v221, v210, v211
    v_mfma_f32_32x32x16_bf16 a[80:95], v[228:231], a[32:35], a[80:95]
    ds_read_b128 v[160:163], v8 offset:768
    ds_read_b128 v[164:167], v8 offset:784
    v_cvt_pk_bf16_f32 v222, v212, v213
    v_cvt_pk_bf16_f32 v223, v214, v215
    s_waitcnt lgkmcnt(8)
    s_cbranch_execz L_disp
    v_mfma_f32_32x32x16_bf16 v[16:31], a[0:3], v[216:219], v[16:31]
    buffer_load_dwordx4 v[116:119], v173, s[28:31], s59 offen sc1
    ds_read_b64_tr_b16 a[24:25], v7 offset:24576
    ds_read_b64_tr_b16 a[26:27], v7 offset:24832
    s_waitcnt vmcnt(23)
    v_fma_mix_f32 v208, v120, v192, v196 op_sel:[0,0,0] op_sel_hi:[1,1,1]
    v_fma_mix_f32 v209, v120, v192, v196 op_sel:[1,1,1] op_sel_hi:[1,1,1]
    v_fma_mix_f32 v210, v121, v193, v197 op_sel:[0,0,0] op_sel_hi:[1,1,1]
    v_mfma_f32_32x32x16_bf16 v[32:47], a[4:7], v[216:219], v[32:47]
    ds_read_b64_tr_b16 a[28:29], v7 offset:32768
    ds_read_b64_tr_b16 a[30:31], v7 offset:33024
    ds_read_b64_tr_b16 a[32:33], v7 offset:40960
    v_fma_mix_f32 v211, v121, v193, v197 op_sel:[1,1,1] op_sel_hi:[1,1,1]
    v_fma_mix_f32 v212, v122, v194, v198 op_sel:[0,0,0] op_sel_hi:[1,1,1]
    v_fma_mix_f32 v213, v122, v194, v198 op_sel:[1,1,1] op_sel_hi:[1,1,1]
    v_fma_mix_f32 v214, v123, v195, v199 op_sel:[0,0,0] op_sel_hi:[1,1,1]
    v_fma_mix_f32 v215, v123, v195, v199 op_sel:[1,1,1] op_sel_hi:[1,1,1]
    v_mfma_f32_32x32x16_bf16 v[48:63], v[216:219], a[8:11], v[48:63]
    ds_read_b64_tr_b16 a[34:35], v7 offset:41216
    ds_read_b128 v[176:179], v9 offset:768
    ds_read_b128 v[180:183], v9 offset:784
    v_cvt_pk_bf16_f32 v224, v208, v209
    v_cvt_pk_bf16_f32 v225, v210, v211
    v_cvt_pk_bf16_f32 v226, v212, v213
    v_cvt_pk_bf16_f32 v227, v214, v215
    s_barrier
    s_waitcnt lgkmcnt(8)
    v_mfma_f32_32x32x16_bf16 v[16:31], a[12:15], v[220:223], v[16:31]
    buffer_load_dwordx4 v[120:123], v174, s[28:31], s59 offen sc1
    ds_read_b64_tr_b16 a[0:1], v4 offset:28672
    ds_read_b64_tr_b16 a[2:3], v4 offset:28928
    s_waitcnt vmcnt(23)
    v_fma_mix_f32 v208, v124, v160, v164 op_sel:[0,0,0] op_sel_hi:[1,1,1]
    s_nop 0
    s_cbranch_execz L_disp
    v_fma_mix_f32 v209, v124, v160, v164 op_sel:[1,1,1] op_sel_hi:[1,1,1]
    v_fma_mix_f32 v210, v125, v161, v165 op_sel:[0,0,0] op_sel_hi:[1,1,1]
    v_fma_mix_f32 v211, v125, v161, v165 op_sel:[1,1,1] op_sel_hi:[1,1,1]
    v_fma_mix_f32 v212, v126, v162, v166 op_sel:[0,0,0] op_sel_hi:[1,1,1]
    v_fma_mix_f32 v213, v126, v162, v166 op_sel:[1,1,1] op_sel_hi:[1,1,1]
    v_fma_mix_f32 v214, v127, v163, v167 op_sel:[0,0,0] op_sel_hi:[1,1,1]
    v_fma_mix_f32 v215, v127, v163, v167 op_sel:[1,1,1] op_sel_hi:[1,1,1]
    v_mfma_f32_32x32x16_bf16 v[32:47], a[16:19], v[220:223], v[32:47]
    ds_read_b64_tr_b16 a[4:5], v4 offset:36864
    ds_read_b64_tr_b16 a[6:7], v4 offset:37120
    ds_read_b64_tr_b16 a[8:9], v4 offset:45056
    v_cvt_pk_bf16_f32 v216, v208, v209
    v_cvt_pk_bf16_f32 v217, v210, v211
    v_cvt_pk_bf16_f32 v218, v212, v213
    v_cvt_pk_bf16_f32 v219, v214, v215
    s_waitcnt vmcnt(22)
    v_fma_mix_f32 v208, v128, v160, v164 op_sel:[0,0,0] op_sel_hi:[1,1,1]
    v_fma_mix_f32 v209, v128, v160, v164 op_sel:[1,1,1] op_sel_hi:[1,1,1]
    v_fma_mix_f32 v210, v129, v161, v165 op_sel:[0,0,0] op_sel_hi:[1,1,1]
    v_mfma_f32_32x32x16_bf16 v[48:63], v[220:223], a[20:23], v[48:63]
    ds_read_b64_tr_b16 a[10:11], v4 offset:45312
    ds_read_b128 v[192:195], v10 offset:768
    ds_read_b128 v[196:199], v10 offset:784
    v_fma_mix_f32 v211, v129, v161, v165 op_sel:[1,1,1] op_sel_hi:[1,1,1]
    v_fma_mix_f32 v212, v130, v162, v166 op_sel:[0,0,0] op_sel_hi:[1,1,1]
    v_fma_mix_f32 v213, v130, v162, v166 op_sel:[1,1,1] op_sel_hi:[1,1,1]
    v_fma_mix_f32 v214, v131, v163, v167 op_sel:[0,0,0] op_sel_hi:[1,1,1]
    v_fma_mix_f32 v215, v131, v163, v167 op_sel:[1,1,1] op_sel_hi:[1,1,1]
    v_cvt_pk_bf16_f32 v228, v208, v209
    v_cvt_pk_bf16_f32 v229, v210, v211
    v_cvt_pk_bf16_f32 v230, v212, v213
    v_cvt_pk_bf16_f32 v231, v214, v215
    s_cbranch_execz L_disp
    s_waitcnt lgkmcnt(8)
    v_mfma_f32_32x32x16_bf16 v[16:31], a[24:27], v[224:227], v[16:31]
    buffer_load_dwordx4 v[124:127], v175, s[28:31], s59 offen sc1
    s_lshl_b32 s26, s3, 17
    s_lshl_b32 s27, s11, 7
    s_add_u32 s26, s26, s27
    s_lshl_b32 s27, s3, 13
    s_mul_i32 s99, s3, 7168
    s_lshl_b32 s98, s3, 10
    s_add_u32 m0, s27, 0x18000
    s_add_u32 s20, s26, 0x0
    buffer_load_dwordx4 v13, s[40:43], s20 offen lds
    s_add_u32 m0, s99, 0x20000
    s_add_u32 s20, s26, 0x40
    buffer_load_dwordx4 v13, s[40:43], s20 offen lds
    ds_read_b64_tr_b16 a[12:13], v5 offset:28672
    ds_read_b64_tr_b16 a[14:15], v5 offset:28928
    s_waitcnt vmcnt(24)
    v_fma_mix_f32 v208, v132, v176, v180 op_sel:[0,0,0] op_sel_hi:[1,1,1]
    v_fma_mix_f32 v209, v132, v176, v180 op_sel:[1,1,1] op_sel_hi:[1,1,1]
    v_fma_mix_f32 v210, v133, v177, v181 op_sel:[0,0,0] op_sel_hi:[1,1,1]
    v_mfma_f32_32x32x16_bf16 v[32:47], a[28:31], v[224:227], v[32:47]
    ds_read_b64_tr_b16 a[16:17], v5 offset:36864
    ds_read_b64_tr_b16 a[18:19], v5 offset:37120
    ds_read_b64_tr_b16 a[20:21], v5 offset:45056
    v_fma_mix_f32 v211, v133, v177, v181 op_sel:[1,1,1] op_sel_hi:[1,1,1]
    v_fma_mix_f32 v212, v134, v178, v182 op_sel:[0,0,0] op_sel_hi:[1,1,1]
    v_fma_mix_f32 v213, v134, v178, v182 op_sel:[1,1,1] op_sel_hi:[1,1,1]
    v_fma_mix_f32 v214, v135, v179, v183 op_sel:[0,0,0] op_sel_hi:[1,1,1]
    v_fma_mix_f32 v215, v135, v179, v183 op_sel:[1,1,1] op_sel_hi:[1,1,1]
    v_mfma_f32_32x32x16_bf16 v[48:63], v[224:227], a[32:35], v[48:63]
    ds_read_b64_tr_b16 a[22:23], v5 offset:45312
    ds_read_b128 v[160:163], v11 offset:768
    ds_read_b128 v[164:167], v11 offset:784
    v_cvt_pk_bf16_f32 v220, v208, v209
    v_cvt_pk_bf16_f32 v221, v210, v211
    s_cbranch_execz L_disp
    v_cvt_pk_bf16_f32 v222, v212, v213
    v_cvt_pk_bf16_f32 v223, v214, v215
    s_waitcnt lgkmcnt(8)
    v_mfma_f32_32x32x16_bf16 v[16:31], a[0:3], v[216:219], v[16:31]
    s_add_u32 m0, s27, 0x18400
    s_add_u32 s20, s26, 0x4000
    buffer_load_dwordx4 v13, s[40:43], s20 offen lds
    s_add_u32 m0, s99, 0x20400
    s_add_u32 s20, s26, 0x4040
    buffer_load_dwordx4 v13, s[40:43], s20 offen lds
    s_add_u32 m0, s27, 0x18800
    s_add_u32 s20, s26, 0x8000
    buffer_load_dwordx4 v13, s[40:43], s20 offen lds
    ds_read_b64_tr_b16 a[24:25], v6 offset:28672
    s_waitcnt vmcnt(26)
    v_fma_mix_f32 v208, v136, v192, v196 op_sel:[0,0,0] op_sel_hi:[1,1,1]
    v_mfma_f32_32x32x16_bf16 v[32:47], a[4:7], v[216:219], v[32:47]
    ds_read_b64_tr_b16 a[26:27], v6 offset:28928
    ds_read_b64_tr_b16 a[28:29], v6 offset:36864
    v_fma_mix_f32 v209, v136, v192, v196 op_sel:[1,1,1] op_sel_hi:[1,1,1]
    v_fma_mix_f32 v210, v137, v193, v197 op_sel:[0,0,0] op_sel_hi:[1,1,1]
    v_fma_mix_f32 v211, v137, v193, v197 op_sel:[1,1,1] op_sel_hi:[1,1,1]
    v_mfma_f32_32x32x16_bf16 v[48:63], v[216:219], a[8:11], v[48:63]
    ds_read_b64_tr_b16 a[30:31], v6 offset:37120
    v_fma_mix_f32 v212, v138, v194, v198 op_sel:[0,0,0] op_sel_hi:[1,1,1]
    v_fma_mix_f32 v213, v138, v194, v198 op_sel:[1,1,1] op_sel_hi:[1,1,1]
    v_fma_mix_f32 v214, v139, v195, v199 op_sel:[0,0,0] op_sel_hi:[1,1,1]
    v_mfma_f32_32x32x16_bf16 a[64:79], a[4:7], v[228:231], a[64:79]
    ds_read_b64_tr_b16 a[32:33], v6 offset:45056
    ds_read_b64_tr_b16 a[34:35], v6 offset:45312
    v_fma_mix_f32 v215, v139, v195, v199 op_sel:[1,1,1] op_sel_hi:[1,1,1]
    v_cvt_pk_bf16_f32 v224, v208, v209
    s_nop 0
    s_cbranch_execz L_disp
    v_cvt_pk_bf16_f32 v225, v210, v211
    v_mfma_f32_32x32x16_bf16 a[80:95], v[228:231], a[8:11], a[80:95]
    ds_read_b128 v[176:179], v8 offset:1024
    ds_read_b128 v[180:183], v8 offset:1040
    v_cvt_pk_bf16_f32 v226, v212, v213
    v_cvt_pk_bf16_f32 v227, v214, v215
    s_waitcnt lgkmcnt(8)
    v_mfma_f32_32x32x16_bf16 v[16:31], a[12:15], v[220:223], v[16:31]
    s_add_u32 m0, s99, 0x20800
    s_add_u32 s20, s26, 0x8040
    buffer_load_dwordx4 v13, s[40:43], s20 offen lds
    s_add_u32 m0, s27, 0x18c00
    s_add_u32 s20, s26, 0xc000
    buffer_load_dwordx4 v13, s[40:43], s20 offen lds
    s_add_u32 m0, s99, 0x20c00
    s_add_u32 s20, s26, 0xc040
    buffer_load_dwordx4 v13, s[40:43], s20 offen lds
    ds_read_b64_tr_b16 a[0:1], v7 offset:28672
    ds_read_b64_tr_b16 a[2:3], v7 offset:28928
    s_waitcnt vmcnt(28)
    v_fma_mix_f32 v208, v140, v160, v164 op_sel:[0,0,0] op_sel_hi:[1,1,1]
    v_fma_mix_f32 v209, v140, v160, v164 op_sel:[1,1,1] op_sel_hi:[1,1,1]
    v_fma_mix_f32 v210, v141, v161, v165 op_sel:[0,0,0] op_sel_hi:[1,1,1]
    v_mfma_f32_32x32x16_bf16 v[32:47], a[16:19], v[220:223], v[32:47]
    ds_read_b64_tr_b16 a[4:5], v7 offset:36864
    ds_read_b64_tr_b16 a[6:7], v7 offset:37120
    ds_read_b64_tr_b16 a[8:9], v7 offset:45056
    v_fma_mix_f32 v211, v141, v161, v165 op_sel:[1,1,1] op_sel_hi:[1,1,1]
    v_fma_mix_f32 v212, v142, v162, v166 op_sel:[0,0,0] op_sel_hi:[1,1,1]
    v_fma_mix_f32 v213, v142, v162, v166 op_sel:[1,1,1] op_sel_hi:[1,1,1]
    v_fma_mix_f32 v214, v143, v163, v167 op_sel:[0,0,0] op_sel_hi:[1,1,1]
    v_fma_mix_f32 v215, v143, v163, v167 op_sel:[1,1,1] op_sel_hi:[1,1,1]
    s_nop 0
    s_cbranch_execz L_disp
    v_mfma_f32_32x32x16_bf16 v[48:63], v[220:223], a[20:23], v[48:63]
    ds_read_b64_tr_b16 a[10:11], v7 offset:45312
    ds_read_b128 v[192:195], v9 offset:1024
    ds_read_b128 v[196:199], v9 offset:1040
    v_cvt_pk_bf16_f32 v216, v208, v209
    v_cvt_pk_bf16_f32 v217, v210, v211
    v_cvt_pk_bf16_f32 v218, v212, v213
    v_cvt_pk_bf16_f32 v219, v214, v215
    s_waitcnt lgkmcnt(8)
    v_mfma_f32_32x32x16_bf16 v[16:31], a[24:27], v[224:227], v[16:31]
    s_add_u32 m0, s27, 0x19000
    s_add_u32 s20, s26, 0x10000
    buffer_load_dwordx4 v13, s[40:43], s20 offen lds
    s_add_u32 m0, s99, 0x21000
    s_add_u32 s20, s26, 0x10040
    buffer_load_dwordx4 v13, s[40:43], s20 offen lds
    s_add_u32 m0, s27, 0x19400
    s_add_u32 s20, s26, 0x14000
    buffer_load_dwordx4 v13, s[40:43], s20 offen lds
    ds_read_b64_tr_b16 a[12:13], v168 offset:0
    ds_read_b64_tr_b16 a[14:15], v168 offset:256
    s_waitcnt vmcnt(30)
    v_fma_mix_f32 v208, v144, v176, v180 op_sel:[0,0,0] op_sel_hi:[1,1,1]
    v_fma_mix_f32 v209, v144, v176, v180 op_sel:[1,1,1] op_sel_hi:[1,1,1]
    v_fma_mix_f32 v210, v145, v177, v181 op_sel:[0,0,0] op_sel_hi:[1,1,1]
    v_fma_mix_f32 v211, v145, v177, v181 op_sel:[1,1,1] op_sel_hi:[1,1,1]
    v_fma_mix_f32 v212, v146, v178, v182 op_sel:[0,0,0] op_sel_hi:[1,1,1]
    v_fma_mix_f32 v213, v146, v178, v182 op_sel:[1,1,1] op_sel_hi:[1,1,1]
    v_fma_mix_f32 v214, v147, v179, v183 op_sel:[0,0,0] op_sel_hi:[1,1,1]
    v_fma_mix_f32 v215, v147, v179, v183 op_sel:[1,1,1] op_sel_hi:[1,1,1]
    v_mfma_f32_32x32x16_bf16 v[32:47], a[28:31], v[224:227], v[32:47]
    ds_read_b64_tr_b16 a[16:17], v168 offset:8192
    s_nop 0
    s_cbranch_execz L_disp
    ds_read_b64_tr_b16 a[18:19], v168 offset:8448
    ds_read_b64_tr_b16 a[20:21], v168 offset:16384
    v_cvt_pk_bf16_f32 v220, v208, v209
    v_cvt_pk_bf16_f32 v221, v210, v211
    v_cvt_pk_bf16_f32 v222, v212, v213
    v_cvt_pk_bf16_f32 v223, v214, v215
    s_waitcnt vmcnt(29)
    v_fma_mix_f32 v208, v148, v176, v180 op_sel:[0,0,0] op_sel_hi:[1,1,1]
    v_fma_mix_f32 v209, v148, v176, v180 op_sel:[1,1,1] op_sel_hi:[1,1,1]
    v_fma_mix_f32 v210, v149, v177, v181 op_sel:[0,0,0] op_sel_hi:[1,1,1]
    v_mfma_f32_32x32x16_bf16 v[48:63], v[224:227], a[32:35], v[48:63]
    ds_read_b64_tr_b16 a[22:23], v168 offset:16640
    ds_read_b128 v[160:163], v10 offset:1024
    ds_read_b128 v[164:167], v10 offset:1040
    v_fma_mix_f32 v211, v149, v177, v181 op_sel:[1,1,1] op_sel_hi:[1,1,1]
    v_fma_mix_f32 v212, v150, v178, v182 op_sel:[0,0,0] op_sel_hi:[1,1,1]
    v_fma_mix_f32 v213, v150, v178, v182 op_sel:[1,1,1] op_sel_hi:[1,1,1]
    v_fma_mix_f32 v214, v151, v179, v183 op_sel:[0,0,0] op_sel_hi:[1,1,1]
    v_fma_mix_f32 v215, v151, v179, v183 op_sel:[1,1,1] op_sel_hi:[1,1,1]
    v_cvt_pk_bf16_f32 v228, v208, v209
    v_cvt_pk_bf16_f32 v229, v210, v211
    v_cvt_pk_bf16_f32 v230, v212, v213
    v_cvt_pk_bf16_f32 v231, v214, v215
    s_waitcnt lgkmcnt(8)
    v_mfma_f32_32x32x16_bf16 v[16:31], a[0:3], v[216:219], v[16:31]
    s_add_u32 m0, s99, 0x21400
    s_add_u32 s20, s26, 0x14040
    buffer_load_dwordx4 v13, s[40:43], s20 offen lds
    s_add_u32 m0, s27, 0x19800
    s_add_u32 s20, s26, 0x18000
    buffer_load_dwordx4 v13, s[40:43], s20 offen lds
    s_add_u32 m0, s99, 0x21800
    s_nop 0
    s_cbranch_execz L_disp
    s_add_u32 s20, s26, 0x18040
    buffer_load_dwordx4 v13, s[40:43], s20 offen lds
    ds_read_b64_tr_b16 a[24:25], v169 offset:0
    ds_read_b64_tr_b16 a[26:27], v169 offset:256
    s_waitcnt vmcnt(31)
    v_fma_mix_f32 v208, v152, v192, v196 op_sel:[0,0,0] op_sel_hi:[1,1,1]
    v_fma_mix_f32 v209, v152, v192, v196 op_sel:[1,1,1] op_sel_hi:[1,1,1]
    v_fma_mix_f32 v210, v153, v193, v197 op_sel:[0,0,0] op_sel_hi:[1,1,1]
    v_mfma_f32_32x32x16_bf16 v[32:47], a[4:7], v[216:219], v[32:47]
    ds_read_b64_tr_b16 a[28:29], v169 offset:8192
    ds_read_b64_tr_b16 a[30:31], v169 offset:8448
    ds_read_b64_tr_b16 a[32:33], v169 offset:16384
    v_fma_mix_f32 v211, v153, v193, v197 op_sel:[1,1,1] op_sel_hi:[1,1,1]
    v_fma_mix_f32 v212, v154, v194, v198 op_sel:[0,0,0] op_sel_hi:[1,1,1]
    v_fma_mix_f32 v213, v154, v194, v198 op_sel:[1,1,1] op_sel_hi:[1,1,1]
    v_fma_mix_f32 v214, v155, v195, v199 op_sel:[0,0,0] op_sel_hi:[1,1,1]
    v_fma_mix_f32 v215, v155, v195, v199 op_sel:[1,1,1] op_sel_hi:[1,1,1]
    v_mfma_f32_32x32x16_bf16 v[48:63], v[216:219], a[8:11], v[48:63]
    ds_read_b64_tr_b16 a[34:35], v169 offset:16640
    ds_read_b128 v[176:179], v11 offset:1024
    ds_read_b128 v[180:183], v11 offset:1040
    v_cvt_pk_bf16_f32 v224, v208, v209
    v_cvt_pk_bf16_f32 v225, v210, v211
    v_cvt_pk_bf16_f32 v226, v212, v213
    v_cvt_pk_bf16_f32 v227, v214, v215
    s_waitcnt lgkmcnt(8)
    v_mfma_f32_32x32x16_bf16 v[16:31], a[12:15], v[220:223], v[16:31]
    s_add_u32 m0, s27, 0x19c00
    s_add_u32 s20, s26, 0x1c000
    buffer_load_dwordx4 v13, s[40:43], s20 offen lds
    s_add_u32 m0, s98, 0x0
    s_add_u32 s20, s26, 0x1c040
    buffer_load_dwordx4 v13, s[40:43], s20 offen lds
    s_cbranch_execz L_disp
    v_lshlrev_b32 v14, 7, v1
    s_mul_i32 s23, s5, 44032
    s_mul_i32 s22, s3, 11008
    s_add_u32 s23, s23, s22
    buffer_load_dword v252, v14, s[44:47], s23 offen
    ds_read_b64_tr_b16 a[0:1], v170 offset:0
    s_waitcnt vmcnt(33)
    v_fma_mix_f32 v208, v156, v160, v164 op_sel:[0,0,0] op_sel_hi:[1,1,1]
    v_mfma_f32_32x32x16_bf16 v[32:47], a[16:19], v[220:223], v[32:47]
    ds_read_b64_tr_b16 a[2:3], v170 offset:256
    ds_read_b64_tr_b16 a[4:5], v170 offset:8192
    v_fma_mix_f32 v209, v156, v160, v164 op_sel:[1,1,1] op_sel_hi:[1,1,1]
    v_fma_mix_f32 v210, v157, v161, v165 op_sel:[0,0,0] op_sel_hi:[1,1,1]
    v_fma_mix_f32 v211, v157, v161, v165 op_sel:[1,1,1] op_sel_hi:[1,1,1]
    v_mfma_f32_32x32x16_bf16 v[48:63], v[220:223], a[20:23], v[48:63]
    ds_read_b64_tr_b16 a[6:7], v170 offset:8448
    v_fma_mix_f32 v212, v158, v162, v166 op_sel:[0,0,0] op_sel_hi:[1,1,1]
    v_fma_mix_f32 v213, v158, v162, v166 op_sel:[1,1,1] op_sel_hi:[1,1,1]
    v_fma_mix_f32 v214, v159, v163, v167 op_sel:[0,0,0] op_sel_hi:[1,1,1]
    v_mfma_f32_32x32x16_bf16 a[64:79], a[16:19], v[228:231], a[64:79]
    ds_read_b64_tr_b16 a[8:9], v170 offset:16384
    ds_read_b64_tr_b16 a[10:11], v170 offset:16640
    v_fma_mix_f32 v215, v159, v163, v167 op_sel:[1,1,1] op_sel_hi:[1,1,1]
    v_cvt_pk_bf16_f32 v216, v208, v209
    v_cvt_pk_bf16_f32 v217, v210, v211
    v_mfma_f32_32x32x16_bf16 a[80:95], v[228:231], a[20:23], a[80:95]
    ds_read_b128 v[192:195], v8 offset:1280
    ds_read_b128 v[196:199], v8 offset:1296
    v_cvt_pk_bf16_f32 v218, v212, v213
    v_cvt_pk_bf16_f32 v219, v214, v215
    s_waitcnt lgkmcnt(8)
    v_mfma_f32_32x32x16_bf16 v[16:31], a[24:27], v[224:227], v[16:31]
    s_mul_i32 s23, s5, 44032
    s_nop 0
    s_cbranch_execz L_disp
    s_mul_i32 s22, s3, 11008
    s_add_u32 s23, s23, s22
    s_add_u32 s23, s23, 8192
    s_mov_b64 exec, 0x3fffff
    buffer_load_dword v252, v14, s[44:47], s23 offen
    s_mov_b64 exec, -1
    v_lshlrev_b32 v14, 7, v1
    s_mul_i32 s23, s3, 21
    s_min_u32 s22, s3, 2
    s_add_u32 s23, s23, s22
    s_add_u32 s23, s23, 0
    s_lshl_b32 s23, s23, 14
    s_mul_i32 s22, s5, 6144
    s_add_u32 s23, s23, s22
    s_mov_b32 exec_lo, 0xffffffff
    s_mov_b32 exec_hi, 0xffff
    buffer_load_dword v252, v14, s[48:51], s23 offen
    s_mov_b64 exec, -1
    ds_read_b64_tr_b16 a[12:13], v171 offset:0
    ds_read_b64_tr_b16 a[14:15], v171 offset:256
    s_waitcnt vmcnt(34)
    v_fma_mix_f32 v208, v64, v176, v180 op_sel:[0,0,0] op_sel_hi:[1,1,1]
    v_fma_mix_f32 v209, v64, v176, v180 op_sel:[1,1,1] op_sel_hi:[1,1,1]
    v_fma_mix_f32 v210, v65, v177, v181 op_sel:[0,0,0] op_sel_hi:[1,1,1]
    v_mfma_f32_32x32x16_bf16 v[32:47], a[28:31], v[224:227], v[32:47]
    ds_read_b64_tr_b16 a[16:17], v171 offset:8192
    ds_read_b64_tr_b16 a[18:19], v171 offset:8448
    ds_read_b64_tr_b16 a[20:21], v171 offset:16384
    v_fma_mix_f32 v211, v65, v177, v181 op_sel:[1,1,1] op_sel_hi:[1,1,1]
    v_fma_mix_f32 v212, v66, v178, v182 op_sel:[0,0,0] op_sel_hi:[1,1,1]
    v_fma_mix_f32 v213, v66, v178, v182 op_sel:[1,1,1] op_sel_hi:[1,1,1]
    v_fma_mix_f32 v214, v67, v179, v183 op_sel:[0,0,0] op_sel_hi:[1,1,1]
    v_fma_mix_f32 v215, v67, v179, v183 op_sel:[1,1,1] op_sel_hi:[1,1,1]
    v_mfma_f32_32x32x16_bf16 v[48:63], v[224:227], a[32:35], v[48:63]
    ds_read_b64_tr_b16 a[22:23], v171 offset:16640
    ds_read_b128 v[160:163], v9 offset:1280
    ds_read_b128 v[164:167], v9 offset:1296
    s_nop 0
    s_cbranch_execz L_disp
    v_cvt_pk_bf16_f32 v220, v208, v209
    v_cvt_pk_bf16_f32 v221, v210, v211
    v_cvt_pk_bf16_f32 v222, v212, v213
    v_cvt_pk_bf16_f32 v223, v214, v215
    s_waitcnt lgkmcnt(8)
    v_mfma_f32_32x32x16_bf16 v[16:31], a[0:3], v[216:219], v[16:31]
    ds_read_b64_tr_b16 a[24:25], v168 offset:4096
    ds_read_b64_tr_b16 a[26:27], v168 offset:4352
    s_waitcnt vmcnt(33)
    v_fma_mix_f32 v208, v68, v192, v196 op_sel:[0,0,0] op_sel_hi:[1,1,1]
    v_fma_mix_f32 v209, v68, v192, v196 op_sel:[1,1,1] op_sel_hi:[1,1,1]
    v_fma_mix_f32 v210, v69, v193, v197 op_sel:[0,0,0] op_sel_hi:[1,1,1]
    v_fma_mix_f32 v211, v69, v193, v197 op_sel:[1,1,1] op_sel_hi:[1,1,1]
    v_fma_mix_f32 v212, v70, v194, v198 op_sel:[0,0,0] op_sel_hi:[1,1,1]
    v_fma_mix_f32 v213, v70, v194, v198 op_sel:[1,1,1] op_sel_hi:[1,1,1]
    v_fma_mix_f32 v214, v71, v195, v199 op_sel:[0,0,0] op_sel_hi:[1,1,1]
    v_fma_mix_f32 v215, v71, v195, v199 op_sel:[1,1,1] op_sel_hi:[1,1,1]
    v_mfma_f32_32x32x16_bf16 v[32:47], a[4:7], v[216:219], v[32:47]
    ds_read_b64_tr_b16 a[28:29], v168 offset:12288
    ds_read_b64_tr_b16 a[30:31], v168 offset:12544
    ds_read_b64_tr_b16 a[32:33], v168 offset:20480
    v_cvt_pk_bf16_f32 v224, v208, v209
    v_cvt_pk_bf16_f32 v225, v210, v211
    v_cvt_pk_bf16_f32 v226, v212, v213
    v_cvt_pk_bf16_f32 v227, v214, v215
    s_waitcnt vmcnt(32)
    v_fma_mix_f32 v208, v72, v192, v196 op_sel:[0,0,0] op_sel_hi:[1,1,1]
    v_fma_mix_f32 v209, v72, v192, v196 op_sel:[1,1,1] op_sel_hi:[1,1,1]
    v_fma_mix_f32 v210, v73, v193, v197 op_sel:[0,0,0] op_sel_hi:[1,1,1]
    v_mfma_f32_32x32x16_bf16 v[48:63], v[216:219], a[8:11], v[48:63]
    ds_read_b64_tr_b16 a[34:35], v168 offset:20736
    ds_read_b128 v[176:179], v10 offset:1280
    ds_read_b128 v[180:183], v10 offset:1296
    s_cbranch_execz L_disp
    v_fma_mix_f32 v211, v73, v193, v197 op_sel:[1,1,1] op_sel_hi:[1,1,1]
    v_fma_mix_f32 v212, v74, v194, v198 op_sel:[0,0,0] op_sel_hi:[1,1,1]
    v_fma_mix_f32 v213, v74, v194, v198 op_sel:[1,1,1] op_sel_hi:[1,1,1]
    v_fma_mix_f32 v214, v75, v195, v199 op_sel:[0,0,0] op_sel_hi:[1,1,1]
    v_fma_mix_f32 v215, v75, v195, v199 op_sel:[1,1,1] op_sel_hi:[1,1,1]
    v_cvt_pk_bf16_f32 v228, v208, v209
    v_cvt_pk_bf16_f32 v229, v210, v211
    v_cvt_pk_bf16_f32 v230, v212, v213
    v_cvt_pk_bf16_f32 v231, v214, v215
    s_waitcnt lgkmcnt(8)
    v_mfma_f32_32x32x16_bf16 v[16:31], a[12:15], v[220:223], v[16:31]
    ds_read_b64_tr_b16 a[0:1], v169 offset:4096
    ds_read_b64_tr_b16 a[2:3], v169 offset:4352
    s_waitcnt vmcnt(31)
    v_fma_mix_f32 v208, v76, v160, v164 op_sel:[0,0,0] op_sel_hi:[1,1,1]
    v_fma_mix_f32 v209, v76, v160, v164 op_sel:[1,1,1] op_sel_hi:[1,1,1]
    v_fma_mix_f32 v210, v77, v161, v165 op_sel:[0,0,0] op_sel_hi:[1,1,1]
    v_mfma_f32_32x32x16_bf16 v[32:47], a[16:19], v[220:223], v[32:47]
    ds_read_b64_tr_b16 a[4:5], v169 offset:12288
    ds_read_b64_tr_b16 a[6:7], v169 offset:12544
    ds_read_b64_tr_b16 a[8:9], v169 offset:20480
    v_fma_mix_f32 v211, v77, v161, v165 op_sel:[1,1,1] op_sel_hi:[1,1,1]
    v_fma_mix_f32 v212, v78, v162, v166 op_sel:[0,0,0] op_sel_hi:[1,1,1]
    v_fma_mix_f32 v213, v78, v162, v166 op_sel:[1,1,1] op_sel_hi:[1,1,1]
    v_fma_mix_f32 v214, v79, v163, v167 op_sel:[0,0,0] op_sel_hi:[1,1,1]
    v_fma_mix_f32 v215, v79, v163, v167 op_sel:[1,1,1] op_sel_hi:[1,1,1]
    v_mfma_f32_32x32x16_bf16 v[48:63], v[220:223], a[20:23], v[48:63]
    ds_read_b64_tr_b16 a[10:11], v169 offset:20736
    ds_read_b128 v[192:195], v11 offset:1280
    ds_read_b128 v[196:199], v11 offset:1296
    v_cvt_pk_bf16_f32 v216, v208, v209
    v_cvt_pk_bf16_f32 v217, v210, v211
    s_nop 0
    s_cbranch_execz L_disp
    v_cvt_pk_bf16_f32 v218, v212, v213
    v_cvt_pk_bf16_f32 v219, v214, v215
    s_waitcnt lgkmcnt(8)
    v_mfma_f32_32x32x16_bf16 v[16:31], a[24:27], v[224:227], v[16:31]
    ds_read_b64_tr_b16 a[12:13], v170 offset:4096
    s_waitcnt vmcnt(30)
    v_fma_mix_f32 v208, v80, v176, v180 op_sel:[0,0,0] op_sel_hi:[1,1,1]
    v_mfma_f32_32x32x16_bf16 v[32:47], a[28:31], v[224:227], v[32:47]
    ds_read_b64_tr_b16 a[14:15], v170 offset:4352
    ds_read_b64_tr_b16 a[16:17], v170 offset:12288
    v_fma_mix_f32 v209, v80, v176, v180 op_sel:[1,1,1] op_sel_hi:[1,1,1]
    v_fma_mix_f32 v210, v81, v177, v181 op_sel:[0,0,0] op_sel_hi:[1,1,1]
    v_fma_mix_f32 v211, v81, v177, v181 op_sel:[1,1,1] op_sel_hi:[1,1,1]
    v_mfma_f32_32x32x16_bf16 v[48:63], v[224:227], a[32:35], v[48:63]
    ds_read_b64_tr_b16 a[18:19], v170 offset:12544
    v_fma_mix_f32 v212, v82, v178, v182 op_sel:[0,0,0] op_sel_hi:[1,1,1]
    v_fma_mix_f32 v213, v82, v178, v182 op_sel:[1,1,1] op_sel_hi:[1,1,1]
    v_fma_mix_f32 v214, v83, v179, v183 op_sel:[0,0,0] op_sel_hi:[1,1,1]
    v_mfma_f32_32x32x16_bf16 a[64:79], a[28:31], v[228:231], a[64:79]
    ds_read_b64_tr_b16 a[20:21], v170 offset:20480
    ds_read_b64_tr_b16 a[22:23], v170 offset:20736
    v_fma_mix_f32 v215, v83, v179, v183 op_sel:[1,1,1] op_sel_hi:[1,1,1]
    v_cvt_pk_bf16_f32 v220, v208, v209
    v_cvt_pk_bf16_f32 v221, v210, v211
    v_mfma_f32_32x32x16_bf16 a[80:95], v[228:231], a[32:35], a[80:95]
    ds_read_b128 v[160:163], v8 offset:1536
    ds_read_b128 v[164:167], v8 offset:1552
    v_cvt_pk_bf16_f32 v222, v212, v213
    v_cvt_pk_bf16_f32 v223, v214, v215
    s_waitcnt lgkmcnt(8)
    v_mfma_f32_32x32x16_bf16 v[16:31], a[0:3], v[216:219], v[16:31]
    ds_read_b64_tr_b16 a[24:25], v171 offset:4096
    ds_read_b64_tr_b16 a[26:27], v171 offset:4352
    s_cbranch_execz L_disp
    s_waitcnt vmcnt(29)
    v_fma_mix_f32 v208, v84, v192, v196 op_sel:[0,0,0] op_sel_hi:[1,1,1]
    v_fma_mix_f32 v209, v84, v192, v196 op_sel:[1,1,1] op_sel_hi:[1,1,1]
    v_fma_mix_f32 v210, v85, v193, v197 op_sel:[0,0,0] op_sel_hi:[1,1,1]
    v_mfma_f32_32x32x16_bf16 v[32:47], a[4:7], v[216:219], v[32:47]
    ds_read_b64_tr_b16 a[28:29], v171 offset:12288
    ds_read_b64_tr_b16 a[30:31], v171 offset:12544
    ds_read_b64_tr_b16 a[32:33], v171 offset:20480
    v_fma_mix_f32 v211, v85, v193, v197 op_sel:[1,1,1] op_sel_hi:[1,1,1]
    v_fma_mix_f32 v212, v86, v194, v198 op_sel:[0,0,0] op_sel_hi:[1,1,1]
    v_fma_mix_f32 v213, v86, v194, v198 op_sel:[1,1,1] op_sel_hi:[1,1,1]
    v_fma_mix_f32 v214, v87, v195, v199 op_sel:[0,0,0] op_sel_hi:[1,1,1]
    v_fma_mix_f32 v215, v87, v195, v199 op_sel:[1,1,1] op_sel_hi:[1,1,1]
    v_mfma_f32_32x32x16_bf16 v[48:63], v[216:219], a[8:11], v[48:63]
    ds_read_b64_tr_b16 a[34:35], v171 offset:20736
    ds_read_b128 v[176:179], v9 offset:1536
    ds_read_b128 v[180:183], v9 offset:1552
    v_cvt_pk_bf16_f32 v224, v208, v209
    v_cvt_pk_bf16_f32 v225, v210, v211
    v_cvt_pk_bf16_f32 v226, v212, v213
    v_cvt_pk_bf16_f32 v227, v214, v215
    s_barrier
    s_waitcnt lgkmcnt(8)
    v_mfma_f32_32x32x16_bf16 v[16:31], a[12:15], v[220:223], v[16:31]
    ds_read_b64_tr_b16 a[0:1], v168 offset:24576
    ds_read_b64_tr_b16 a[2:3], v168 offset:24832
    s_waitcnt vmcnt(28)
    v_fma_mix_f32 v208, v88, v160, v164 op_sel:[0,0,0] op_sel_hi:[1,1,1]
    v_fma_mix_f32 v209, v88, v160, v164 op_sel:[1,1,1] op_sel_hi:[1,1,1]
    v_fma_mix_f32 v210, v89, v161, v165 op_sel:[0,0,0] op_sel_hi:[1,1,1]
    v_fma_mix_f32 v211, v89, v161, v165 op_sel:[1,1,1] op_sel_hi:[1,1,1]
    v_fma_mix_f32 v212, v90, v162, v166 op_sel:[0,0,0] op_sel_hi:[1,1,1]
    v_fma_mix_f32 v213, v90, v162, v166 op_sel:[1,1,1] op_sel_hi:[1,1,1]
    s_nop 0
    s_cbranch_execz L_disp
    v_fma_mix_f32 v214, v91, v163, v167 op_sel:[0,0,0] op_sel_hi:[1,1,1]
    v_fma_mix_f32 v215, v91, v163, v167 op_sel:[1,1,1] op_sel_hi:[1,1,1]
    v_mfma_f32_32x32x16_bf16 v[32:47], a[16:19], v[220:223], v[32:47]
    ds_read_b64_tr_b16 a[4:5], v168 offset:32768
    ds_read_b64_tr_b16 a[6:7], v168 offset:33024
    ds_read_b64_tr_b16 a[8:9], v168 offset:40960
    v_cvt_pk_bf16_f32 v216, v208, v209
    v_cvt_pk_bf16_f32 v217, v210, v211
    v_cvt_pk_bf16_f32 v218, v212, v213
    v_cvt_pk_bf16_f32 v219, v214, v215
    s_waitcnt vmcnt(27)
    v_fma_mix_f32 v208, v92, v160, v164 op_sel:[0,0,0] op_sel_hi:[1,1,1]
    v_fma_mix_f32 v209, v92, v160, v164 op_sel:[1,1,1] op_sel_hi:[1,1,1]
    v_fma_mix_f32 v210, v93, v161, v165 op_sel:[0,0,0] op_sel_hi:[1,1,1]
    v_mfma_f32_32x32x16_bf16 v[48:63], v[220:223], a[20:23], v[48:63]
    ds_read_b64_tr_b16 a[10:11], v168 offset:41216
    ds_read_b128 v[192:195], v10 offset:1536
    ds_read_b128 v[196:199], v10 offset:1552
    v_fma_mix_f32 v211, v93, v161, v165 op_sel:[1,1,1] op_sel_hi:[1,1,1]
    v_fma_mix_f32 v212, v94, v162, v166 op_sel:[0,0,0] op_sel_hi:[1,1,1]
    v_fma_mix_f32 v213, v94, v162, v166 op_sel:[1,1,1] op_sel_hi:[1,1,1]
    v_fma_mix_f32 v214, v95, v163, v167 op_sel:[0,0,0] op_sel_hi:[1,1,1]
    v_fma_mix_f32 v215, v95, v163, v167 op_sel:[1,1,1] op_sel_hi:[1,1,1]
    v_cvt_pk_bf16_f32 v228, v208, v209
    v_cvt_pk_bf16_f32 v229, v210, v211
    v_cvt_pk_bf16_f32 v230, v212, v213
    v_cvt_pk_bf16_f32 v231, v214, v215
    s_waitcnt lgkmcnt(8)
    v_mfma_f32_32x32x16_bf16 v[16:31], a[24:27], v[224:227], v[16:31]
    ds_read_b64_tr_b16 a[12:13], v169 offset:24576
    ds_read_b64_tr_b16 a[14:15], v169 offset:24832
    s_waitcnt vmcnt(26)
    v_fma_mix_f32 v208, v96, v176, v180 op_sel:[0,0,0] op_sel_hi:[1,1,1]
    s_cbranch_execz L_disp
    v_fma_mix_f32 v209, v96, v176, v180 op_sel:[1,1,1] op_sel_hi:[1,1,1]
    v_fma_mix_f32 v210, v97, v177, v181 op_sel:[0,0,0] op_sel_hi:[1,1,1]
    v_mfma_f32_32x32x16_bf16 v[32:47], a[28:31], v[224:227], v[32:47]
    ds_read_b64_tr_b16 a[16:17], v169 offset:32768
    ds_read_b64_tr_b16 a[18:19], v169 offset:33024
    ds_read_b64_tr_b16 a[20:21], v169 offset:40960
    v_fma_mix_f32 v211, v97, v177, v181 op_sel:[1,1,1] op_sel_hi:[1,1,1]
    v_fma_mix_f32 v212, v98, v178, v182 op_sel:[0,0,0] op_sel_hi:[1,1,1]
    v_fma_mix_f32 v213, v98, v178, v182 op_sel:[1,1,1] op_sel_hi:[1,1,1]
    v_fma_mix_f32 v214, v99, v179, v183 op_sel:[0,0,0] op_sel_hi:[1,1,1]
    v_fma_mix_f32 v215, v99, v179, v183 op_sel:[1,1,1] op_sel_hi:[1,1,1]
    v_mfma_f32_32x32x16_bf16 v[48:63], v[224:227], a[32:35], v[48:63]
    ds_read_b64_tr_b16 a[22:23], v169 offset:41216
    ds_read_b128 v[160:163], v11 offset:1536
    ds_read_b128 v[164:167], v11 offset:1552
    v_cvt_pk_bf16_f32 v220, v208, v209
    v_cvt_pk_bf16_f32 v221, v210, v211
    v_cvt_pk_bf16_f32 v222, v212, v213
    v_cvt_pk_bf16_f32 v223, v214, v215
    s_waitcnt lgkmcnt(8)
    v_mfma_f32_32x32x16_bf16 v[16:31], a[0:3], v[216:219], v[16:31]
    v_lshlrev_b32 v237, 2, v1
    s_mov_b32 s21, 0x12000
    buffer_load_dword v236, v237, s[28:31], s21 offen sc1
    ds_read_b64_tr_b16 a[24:25], v170 offset:24576
    s_waitcnt vmcnt(26)
    v_fma_mix_f32 v208, v100, v192, v196 op_sel:[0,0,0] op_sel_hi:[1,1,1]
    v_mfma_f32_32x32x16_bf16 v[32:47], a[4:7], v[216:219], v[32:47]
    ds_read_b64_tr_b16 a[26:27], v170 offset:24832
    ds_read_b64_tr_b16 a[28:29], v170 offset:32768
    v_fma_mix_f32 v209, v100, v192, v196 op_sel:[1,1,1] op_sel_hi:[1,1,1]
    v_fma_mix_f32 v210, v101, v193, v197 op_sel:[0,0,0] op_sel_hi:[1,1,1]
    v_fma_mix_f32 v211, v101, v193, v197 op_sel:[1,1,1] op_sel_hi:[1,1,1]
    s_cbranch_execz L_disp
    v_mfma_f32_32x32x16_bf16 v[48:63], v[216:219], a[8:11], v[48:63]
    ds_read_b64_tr_b16 a[30:31], v170 offset:33024
    v_fma_mix_f32 v212, v102, v194, v198 op_sel:[0,0,0] op_sel_hi:[1,1,1]
    v_fma_mix_f32 v213, v102, v194, v198 op_sel:[1,1,1] op_sel_hi:[1,1,1]
    v_fma_mix_f32 v214, v103, v195, v199 op_sel:[0,0,0] op_sel_hi:[1,1,1]
    v_mfma_f32_32x32x16_bf16 a[64:79], a[4:7], v[228:231], a[64:79]
    ds_read_b64_tr_b16 a[32:33], v170 offset:40960
    ds_read_b64_tr_b16 a[34:35], v170 offset:41216
    v_fma_mix_f32 v215, v103, v195, v199 op_sel:[1,1,1] op_sel_hi:[1,1,1]
    v_cvt_pk_bf16_f32 v224, v208, v209
    v_cvt_pk_bf16_f32 v225, v210, v211
    v_mfma_f32_32x32x16_bf16 a[80:95], v[228:231], a[8:11], a[80:95]
    ds_read_b128 v[176:179], v8 offset:1792
    ds_read_b128 v[180:183], v8 offset:1808
    v_cvt_pk_bf16_f32 v226, v212, v213
    v_cvt_pk_bf16_f32 v227, v214, v215
    s_waitcnt lgkmcnt(8)
    v_mfma_f32_32x32x16_bf16 v[16:31], a[12:15], v[220:223], v[16:31]
    ds_read_b64_tr_b16 a[0:1], v171 offset:24576
    ds_read_b64_tr_b16 a[2:3], v171 offset:24832
    s_waitcnt vmcnt(25)
    v_fma_mix_f32 v208, v104, v160, v164 op_sel:[0,0,0] op_sel_hi:[1,1,1]
    v_fma_mix_f32 v209, v104, v160, v164 op_sel:[1,1,1] op_sel_hi:[1,1,1]
    v_fma_mix_f32 v210, v105, v161, v165 op_sel:[0,0,0] op_sel_hi:[1,1,1]
    v_mfma_f32_32x32x16_bf16 v[32:47], a[16:19], v[220:223], v[32:47]
    ds_read_b64_tr_b16 a[4:5], v171 offset:32768
    ds_read_b64_tr_b16 a[6:7], v171 offset:33024
    ds_read_b64_tr_b16 a[8:9], v171 offset:40960
    v_fma_mix_f32 v211, v105, v161, v165 op_sel:[1,1,1] op_sel_hi:[1,1,1]
    v_fma_mix_f32 v212, v106, v162, v166 op_sel:[0,0,0] op_sel_hi:[1,1,1]
    v_fma_mix_f32 v213, v106, v162, v166 op_sel:[1,1,1] op_sel_hi:[1,1,1]
    v_fma_mix_f32 v214, v107, v163, v167 op_sel:[0,0,0] op_sel_hi:[1,1,1]
    s_nop 0
    s_cbranch_execz L_disp
    v_fma_mix_f32 v215, v107, v163, v167 op_sel:[1,1,1] op_sel_hi:[1,1,1]
    v_mfma_f32_32x32x16_bf16 v[48:63], v[220:223], a[20:23], v[48:63]
    ds_read_b64_tr_b16 a[10:11], v171 offset:41216
    ds_read_b128 v[192:195], v9 offset:1792
    ds_read_b128 v[196:199], v9 offset:1808
    v_cvt_pk_bf16_f32 v216, v208, v209
    v_cvt_pk_bf16_f32 v217, v210, v211
    v_cvt_pk_bf16_f32 v218, v212, v213
    v_cvt_pk_bf16_f32 v219, v214, v215
    s_waitcnt lgkmcnt(8)
    v_mfma_f32_32x32x16_bf16 v[16:31], a[24:27], v[224:227], v[16:31]
    ds_read_b64_tr_b16 a[12:13], v168 offset:28672
    ds_read_b64_tr_b16 a[14:15], v168 offset:28928
    s_waitcnt vmcnt(24)
    v_fma_mix_f32 v208, v108, v176, v180 op_sel:[0,0,0] op_sel_hi:[1,1,1]
    v_fma_mix_f32 v209, v108, v176, v180 op_sel:[1,1,1] op_sel_hi:[1,1,1]
    v_fma_mix_f32 v210, v109, v177, v181 op_sel:[0,0,0] op_sel_hi:[1,1,1]
    v_fma_mix_f32 v211, v109, v177, v181 op_sel:[1,1,1] op_sel_hi:[1,1,1]
    v_fma_mix_f32 v212, v110, v178, v182 op_sel:[0,0,0] op_sel_hi:[1,1,1]
    v_fma_mix_f32 v213, v110, v178, v182 op_sel:[1,1,1] op_sel_hi:[1,1,1]
    v_fma_mix_f32 v214, v111, v179, v183 op_sel:[0,0,0] op_sel_hi:[1,1,1]
    v_fma_mix_f32 v215, v111, v179, v183 op_sel:[1,1,1] op_sel_hi:[1,1,1]
    v_mfma_f32_32x32x16_bf16 v[32:47], a[28:31], v[224:227], v[32:47]
    ds_read_b64_tr_b16 a[16:17], v168 offset:36864
    ds_read_b64_tr_b16 a[18:19], v168 offset:37120
    ds_read_b64_tr_b16 a[20:21], v168 offset:45056
    v_cvt_pk_bf16_f32 v220, v208, v209
    v_cvt_pk_bf16_f32 v221, v210, v211
    v_cvt_pk_bf16_f32 v222, v212, v213
    v_cvt_pk_bf16_f32 v223, v214, v215
    s_waitcnt vmcnt(23)
    v_fma_mix_f32 v208, v112, v176, v180 op_sel:[0,0,0] op_sel_hi:[1,1,1]
    v_fma_mix_f32 v209, v112, v176, v180 op_sel:[1,1,1] op_sel_hi:[1,1,1]
    s_cbranch_execz L_disp
    v_fma_mix_f32 v210, v113, v177, v181 op_sel:[0,0,0] op_sel_hi:[1,1,1]
    v_mfma_f32_32x32x16_bf16 v[48:63], v[224:227], a[32:35], v[48:63]
    ds_read_b64_tr_b16 a[22:23], v168 offset:45312
    ds_read_b128 v[160:163], v10 offset:1792
    ds_read_b128 v[164:167], v10 offset:1808
    v_fma_mix_f32 v211, v113, v177, v181 op_sel:[1,1,1] op_sel_hi:[1,1,1]
    v_fma_mix_f32 v212, v114, v178, v182 op_sel:[0,0,0] op_sel_hi:[1,1,1]
    v_fma_mix_f32 v213, v114, v178, v182 op_sel:[1,1,1] op_sel_hi:[1,1,1]
    v_fma_mix_f32 v214, v115, v179, v183 op_sel:[0,0,0] op_sel_hi:[1,1,1]
    v_fma_mix_f32 v215, v115, v179, v183 op_sel:[1,1,1] op_sel_hi:[1,1,1]
    v_cvt_pk_bf16_f32 v228, v208, v209
    v_cvt_pk_bf16_f32 v229, v210, v211
    v_cvt_pk_bf16_f32 v230, v212, v213
    v_cvt_pk_bf16_f32 v231, v214, v215
    s_waitcnt lgkmcnt(8)
    v_mfma_f32_32x32x16_bf16 v[16:31], a[0:3], v[216:219], v[16:31]
    ds_read_b64_tr_b16 a[24:25], v169 offset:28672
    ds_read_b64_tr_b16 a[26:27], v169 offset:28928
    s_waitcnt vmcnt(22)
    v_fma_mix_f32 v208, v116, v192, v196 op_sel:[0,0,0] op_sel_hi:[1,1,1]
    v_fma_mix_f32 v209, v116, v192, v196 op_sel:[1,1,1] op_sel_hi:[1,1,1]
    v_fma_mix_f32 v210, v117, v193, v197 op_sel:[0,0,0] op_sel_hi:[1,1,1]
    v_mfma_f32_32x32x16_bf16 v[32:47], a[4:7], v[216:219], v[32:47]
    ds_read_b64_tr_b16 a[28:29], v169 offset:36864
    ds_read_b64_tr_b16 a[30:31], v169 offset:37120
    ds_read_b64_tr_b16 a[32:33], v169 offset:45056
    v_fma_mix_f32 v211, v117, v193, v197 op_sel:[1,1,1] op_sel_hi:[1,1,1]
    v_fma_mix_f32 v212, v118, v194, v198 op_sel:[0,0,0] op_sel_hi:[1,1,1]
    v_fma_mix_f32 v213, v118, v194, v198 op_sel:[1,1,1] op_sel_hi:[1,1,1]
    v_fma_mix_f32 v214, v119, v195, v199 op_sel:[0,0,0] op_sel_hi:[1,1,1]
    v_fma_mix_f32 v215, v119, v195, v199 op_sel:[1,1,1] op_sel_hi:[1,1,1]
    v_mfma_f32_32x32x16_bf16 v[48:63], v[216:219], a[8:11], v[48:63]
    s_nop 0
    s_cbranch_execz L_disp
    ds_read_b64_tr_b16 a[34:35], v169 offset:45312
    ds_read_b128 v[176:179], v11 offset:1792
    ds_read_b128 v[180:183], v11 offset:1808
    v_cvt_pk_bf16_f32 v224, v208, v209
    v_cvt_pk_bf16_f32 v225, v210, v211
    v_cvt_pk_bf16_f32 v226, v212, v213
    v_cvt_pk_bf16_f32 v227, v214, v215
    s_waitcnt lgkmcnt(8)
    v_mfma_f32_32x32x16_bf16 v[16:31], a[12:15], v[220:223], v[16:31]
    ds_read_b64_tr_b16 a[0:1], v170 offset:28672
    s_waitcnt vmcnt(21)
    v_fma_mix_f32 v208, v120, v160, v164 op_sel:[0,0,0] op_sel_hi:[1,1,1]
    v_mfma_f32_32x32x16_bf16 v[32:47], a[16:19], v[220:223], v[32:47]
    ds_read_b64_tr_b16 a[2:3], v170 offset:28928
    v_fma_mix_f32 v209, v120, v160, v164 op_sel:[1,1,1] op_sel_hi:[1,1,1]
    v_fma_mix_f32 v210, v121, v161, v165 op_sel:[0,0,0] op_sel_hi:[1,1,1]
    v_fma_mix_f32 v211, v121, v161, v165 op_sel:[1,1,1] op_sel_hi:[1,1,1]
    v_mfma_f32_32x32x16_bf16 v[48:63], v[220:223], a[20:23], v[48:63]
    ds_read_b64_tr_b16 a[4:5], v170 offset:36864
    v_fma_mix_f32 v212, v122, v162, v166 op_sel:[0,0,0] op_sel_hi:[1,1,1]
    v_fma_mix_f32 v213, v122, v162, v166 op_sel:[1,1,1] op_sel_hi:[1,1,1]
    v_fma_mix_f32 v214, v123, v163, v167 op_sel:[0,0,0] op_sel_hi:[1,1,1]
    v_mfma_f32_32x32x16_bf16 a[64:79], a[16:19], v[228:231], a[64:79]
    ds_read_b64_tr_b16 a[6:7], v170 offset:37120
    v_fma_mix_f32 v215, v123, v163, v167 op_sel:[1,1,1] op_sel_hi:[1,1,1]
    v_cvt_pk_bf16_f32 v216, v208, v209
    v_cvt_pk_bf16_f32 v217, v210, v211
    v_mfma_f32_32x32x16_bf16 a[80:95], v[228:231], a[20:23], a[80:95]
    ds_read_b64_tr_b16 a[8:9], v170 offset:45056
    ds_read_b64_tr_b16 a[10:11], v170 offset:45312
    v_cvt_pk_bf16_f32 v218, v212, v213
    v_cvt_pk_bf16_f32 v219, v214, v215
    s_waitcnt lgkmcnt(6)
    s_cbranch_execz L_disp
    v_mfma_f32_32x32x16_bf16 v[16:31], a[24:27], v[224:227], v[16:31]
    ds_read_b64_tr_b16 a[12:13], v171 offset:28672
    ds_read_b64_tr_b16 a[14:15], v171 offset:28928
    s_waitcnt vmcnt(20)
    v_fma_mix_f32 v208, v124, v176, v180 op_sel:[0,0,0] op_sel_hi:[1,1,1]
    v_fma_mix_f32 v209, v124, v176, v180 op_sel:[1,1,1] op_sel_hi:[1,1,1]
    v_fma_mix_f32 v210, v125, v177, v181 op_sel:[0,0,0] op_sel_hi:[1,1,1]
    v_mfma_f32_32x32x16_bf16 v[32:47], a[28:31], v[224:227], v[32:47]
    ds_read_b64_tr_b16 a[16:17], v171 offset:36864
    ds_read_b64_tr_b16 a[18:19], v171 offset:37120
    v_fma_mix_f32 v211, v125, v177, v181 op_sel:[1,1,1] op_sel_hi:[1,1,1]
    v_fma_mix_f32 v212, v126, v178, v182 op_sel:[0,0,0] op_sel_hi:[1,1,1]
    v_fma_mix_f32 v213, v126, v178, v182 op_sel:[1,1,1] op_sel_hi:[1,1,1]
    v_fma_mix_f32 v214, v127, v179, v183 op_sel:[0,0,0] op_sel_hi:[1,1,1]
    v_fma_mix_f32 v215, v127, v179, v183 op_sel:[1,1,1] op_sel_hi:[1,1,1]
    v_mfma_f32_32x32x16_bf16 v[48:63], v[224:227], a[32:35], v[48:63]
    ds_read_b64_tr_b16 a[20:21], v171 offset:45056
    ds_read_b64_tr_b16 a[22:23], v171 offset:45312
    v_cvt_pk_bf16_f32 v220, v208, v209
    v_cvt_pk_bf16_f32 v221, v210, v211
    v_cvt_pk_bf16_f32 v222, v212, v213
    v_cvt_pk_bf16_f32 v223, v214, v215
    s_waitcnt lgkmcnt(6)
    v_mfma_f32_32x32x16_bf16 v[16:31], a[0:3], v[216:219], v[16:31]
    v_mfma_f32_32x32x16_bf16 v[32:47], a[4:7], v[216:219], v[32:47]
    v_mfma_f32_32x32x16_bf16 v[48:63], v[216:219], a[8:11], v[48:63]
    s_waitcnt lgkmcnt(0)
    v_mfma_f32_32x32x16_bf16 v[16:31], a[12:15], v[220:223], v[16:31]
    v_mfma_f32_32x32x16_bf16 v[32:47], a[16:19], v[220:223], v[32:47]
    v_mfma_f32_32x32x16_bf16 v[48:63], v[220:223], a[20:23], v[48:63]
    s_waitcnt vmcnt(4)
    s_barrier
    s_mul_i32 s21, s3, 6144
    s_add_u32 s21, s21, 4096
    s_cbranch_execz L_disp
    v_add_u32 v14, s21, v2
    ds_write_b128 v14, a[64:67] offset:0
    ds_write_b128 v14, a[68:71] offset:1024
    ds_write_b128 v14, a[72:75] offset:2048
    ds_write_b128 v14, a[76:79] offset:3072
    ds_write_b128 v14, a[88:91] offset:4096
    ds_write_b128 v14, a[92:95] offset:5120
    v_cvt_pk_bf16_f32 v96, v16, v17
    v_cvt_pk_bf16_f32 v97, v18, v19
    v_cvt_pk_bf16_f32 v98, v20, v21
    v_cvt_pk_bf16_f32 v99, v22, v23
    v_cvt_pk_bf16_f32 v100, v24, v25
    v_cvt_pk_bf16_f32 v101, v26, v27
    v_cvt_pk_bf16_f32 v102, v28, v29
    v_cvt_pk_bf16_f32 v103, v30, v31
    v_cvt_pk_bf16_f32 v104, v32, v33
    v_cvt_pk_bf16_f32 v105, v34, v35
    v_cvt_pk_bf16_f32 v106, v36, v37
    v_cvt_pk_bf16_f32 v107, v38, v39
    v_cvt_pk_bf16_f32 v108, v40, v41
    v_cvt_pk_bf16_f32 v109, v42, v43
    v_cvt_pk_bf16_f32 v110, v44, v45
    v_cvt_pk_bf16_f32 v111, v46, v47
    v_cvt_pk_bf16_f32 v112, v48, v49
    v_cvt_pk_bf16_f32 v113, v50, v51
    v_cvt_pk_bf16_f32 v114, v52, v53
    v_cvt_pk_bf16_f32 v115, v54, v55
    v_cvt_pk_bf16_f32 v116, v56, v57
    v_cvt_pk_bf16_f32 v117, v58, v59
    v_cvt_pk_bf16_f32 v118, v60, v61
    v_cvt_pk_bf16_f32 v119, v62, v63
    s_mul_i32 s21, s3, 3072
    s_cbranch_execz L_disp
    s_add_u32 s21, s21, 28672
    v_add_u32 v15, s21, v2
    s_cmp_ge_u32 s3, 2
    s_cbranch_scc1 L_noex
    ds_write_b128 v15, v[104:107]
    ds_write_b128 v15, v[108:111] offset:1024
    ds_write_b128 v15, v[116:119] offset:2048
L_noex:
    v_mfma_f32_32x32x16_bf16 v[16:31], v[104:107], v[96:99], 0
    v_mfma_f32_32x32x16_bf16 v[32:47], v[108:111], v[100:103], 0
    v_lshrrev_b32 v4, 2, v1
    v_and_b32 v5, 3, v1
    v_lshlrev_b32 v5, 4, v5
    v_mul_u32_u24 v4, 2752, v4
    v_add_u32 v4, v4, v5
    v_mov_b32 v3, v13
    s_lshl_b32 s27, s13, 14
    s_add_u32 s27, s27, 98304
    v_add_u32 v10, s27, v253
    s_mul_i32 s27, s13, 14336
    s_add_u32 s27, s27, 131072
    v_add_u32 v11, s27, v253
    s_lshl_b32 s27, s13, 11
    v_add_u32 v12, s27, v253
    s_mov_b32 s21, 0x12000
    s_waitcnt vmcnt(0)
    s_mov_b32 s17, 0
    s_branch slp_8
sl_6:
    buffer_load_dword v236, v237, s[28:31], s21 offen sc1
    s_add_u32 s17, s17, 1
    s_waitcnt vmcnt(0)
slp_8:
    v_xor_b32 v236, s6, v236
    v_cmp_ne_u32 vcc, 0, v236
    s_nop 4
    s_cbranch_vccz sld_7
    s_cmp_lt_u32 s17, 30000
    s_cbranch_scc1 sl_6
sld_7:
    s_mov_b32 s21, 0x12000
    v_and_b32 v186, 31, v1
    v_lshrrev_b32 v187, 5, v1
    v_lshlrev_b32 v186, 11, v186
    v_lshl_add_u32 v186, v187, 4, v186
    v_lshlrev_b32 v187, 5, v187
    s_lshr_b32 s17, s14, 1
    s_lshl_b32 s17, s17, 16
    s_lshl_b32 s18, s12, 10
    s_add_u32 s17, s17, s18
    s_lshl_b32 s18, s15, 6
    s_add_u32 s17, s17, s18
    s_cbranch_execz L_disp
    s_lshl_b32 s18, s15, 7
    s_add_u32 s18, s18, 0x1c000
    s_add_u32 s19, s18, 4096
    s_mov_b32 s21, 0x1e400
    v_lshrrev_b32 v188, 3, v1
    v_lshlrev_b32 v189, 11, v188
    v_add_u32 v189, 2048, v189
    v_cmp_eq_u32 vcc, 0, v188
    s_nop 1
    v_cndmask_b32 v189, v189, 0, vcc
    v_and_b32 v188, 7, v1
    v_lshl_add_u32 v189, v188, 4, v189
    s_lshl_b32 s19, s3, 9
    s_add_u32 s19, s19, 159744
    s_mov_b32 m0, s19
    s_mov_b64 exec, 0xffffff
    buffer_load_dwordx4 v189, s[28:31], s18 offen sc1 lds
    s_mov_b64 exec, -1
    buffer_load_dwordx4 a[160:163], v186, s[32:35], s17 offen
    buffer_load_dwordx4 a[164:167], v186, s[32:35], s17 offen offset:32
    buffer_load_dwordx4 a[168:171], v2, s[28:31], s21 offen sc1
    buffer_load_dwordx4 a[172:175], v2, s[28:31], s21 offen offset:1024 sc1
    s_mul_i32 s96, s8, 3
    s_lshl_b32 s97, s8, 1
    s_add_u32 s97, s97, 11
    s_cmp_lt_u32 s8, 11
    s_cselect_b32 s96, s96, s97
    s_cselect_b32 s21, 128, 0
    s_lshl_b32 s98, s96, 6
    s_mul_i32 s97, s3, 220160
    s_add_u32 s98, s98, s97
    s_add_u32 s97, s98, s21
    s_mul_i32 s99, s3, 15360
    s_add_u32 m0, s99, 0x9000
    s_add_u32 s20, s98, 0x81000
    buffer_load_dwordx4 v4, s[44:47], s20 offen lds
    s_add_u32 m0, s99, 0x9400
    s_add_u32 s20, s98, 0x81040
    buffer_load_dwordx4 v4, s[44:47], s20 offen lds
    s_waitcnt lgkmcnt(0)
    s_barrier
    s_cbranch_execz L_disp
    s_cmp_ge_u32 s3, 2
    s_nop 0
    s_cbranch_scc1 L_hi_waves
    s_lshl_b32 s21, s3, 3
    v_subrev_u32 v14, s21, v1
    v_and_b32 v14, 31, v14
    v_and_b32 v15, 32, v1
    v_or_b32 v14, v14, v15
    v_lshlrev_b32 v14, 4, v14
    v_add_u32 v14, 4096, v14
    s_xor_b32 s21, s3, 1
    s_lshl_b32 s21, s21, 10
    s_add_u32 s21, s21, 8192
    v_add_u32 v15, s21, v2
    ds_read_b128 v[148:151], v14 offset:0
    ds_read_b128 v[152:155], v14 offset:1024
    ds_read_b128 v[156:159], v14 offset:2048
    ds_read_b128 v[160:163], v14 offset:3072
    ds_read_b128 v[164:167], v14 offset:6144
    ds_read_b128 v[168:171], v14 offset:7168
    ds_read_b128 v[172:175], v14 offset:8192
    ds_read_b128 v[176:179], v14 offset:9216
    ds_read_b128 v[180:183], v14 offset:12288
    ds_read_b128 v[184:187], v14 offset:13312
    ds_read_b128 v[188:191], v14 offset:14336
    ds_read_b128 v[192:195], v14 offset:15360
    ds_read_b128 v[196:199], v14 offset:18432
    ds_read_b128 v[200:203], v14 offset:19456
    ds_read_b128 v[204:207], v14 offset:20480
    ds_read_b128 v[208:211], v14 offset:21504
    ds_read_b128 v[212:215], v15 offset:0
    ds_read_b128 v[216:219], v15 offset:6144
    ds_read_b128 v[220:223], v15 offset:12288
    ds_read_b128 v[224:227], v15 offset:18432
    s_waitcnt lgkmcnt(0)
    v_add_f32 v148, v148, v164
    v_add_f32 v149, v149, v165
    v_add_f32 v150, v150, v166
    v_add_f32 v151, v151, v167
    v_add_f32 v152, v152, v168
    v_add_f32 v153, v153, v169
    s_cbranch_execz L_disp
    v_add_f32 v154, v154, v170
    v_add_f32 v155, v155, v171
    v_add_f32 v156, v156, v172
    v_add_f32 v157, v157, v173
    v_add_f32 v158, v158, v174
    v_add_f32 v159, v159, v175
    v_add_f32 v160, v160, v176
    v_add_f32 v161, v161, v177
    v_add_f32 v162, v162, v178
    v_add_f32 v163, v163, v179
    v_add_f32 v180, v180, v196
    v_add_f32 v181, v181, v197
    v_add_f32 v182, v182, v198
    v_add_f32 v183, v183, v199
    v_add_f32 v184, v184, v200
    v_add_f32 v185, v185, v201
    v_add_f32 v186, v186, v202
    v_add_f32 v187, v187, v203
    v_add_f32 v188, v188, v204
    v_add_f32 v189, v189, v205
    v_add_f32 v190, v190, v206
    v_add_f32 v191, v191, v207
    v_add_f32 v192, v192, v208
    v_add_f32 v193, v193, v209
    v_add_f32 v194, v194, v210
    v_add_f32 v195, v195, v211
    v_add_f32 v148, v148, v180
    v_add_f32 v149, v149, v181
    v_add_f32 v150, v150, v182
    v_add_f32 v151, v151, v183
    v_add_f32 v152, v152, v184
    v_add_f32 v153, v153, v185
    v_add_f32 v154, v154, v186
    v_add_f32 v155, v155, v187
    v_add_f32 v156, v156, v188
    v_add_f32 v157, v157, v189
    v_add_f32 v158, v158, v190
    v_add_f32 v159, v159, v191
    v_add_f32 v160, v160, v192
    v_add_f32 v161, v161, v193
    v_add_f32 v162, v162, v194
    v_add_f32 v163, v163, v195
    v_add_f32 v212, v212, v216
    v_add_f32 v213, v213, v217
    v_add_f32 v214, v214, v218
    v_add_f32 v215, v215, v219
    v_add_f32 v220, v220, v224
    v_add_f32 v221, v221, v225
    v_add_f32 v222, v222, v226
    v_add_f32 v223, v223, v227
    v_add_f32 v212, v212, v220
    v_add_f32 v213, v213, v221
    v_add_f32 v214, v214, v222
    v_add_f32 v215, v215, v223
    v_cvt_pk_bf16_f32 v120, v148, v149
    v_cvt_pk_bf16_f32 v121, v150, v151
    v_cvt_pk_bf16_f32 v122, v152, v153
    v_cvt_pk_bf16_f32 v123, v154, v155
    s_nop 0
    s_cbranch_execz L_disp
    v_cvt_pk_bf16_f32 v124, v156, v157
    v_cvt_pk_bf16_f32 v125, v158, v159
    v_cvt_pk_bf16_f32 v126, v160, v161
    v_cvt_pk_bf16_f32 v127, v162, v163
    v_cvt_pk_bf16_f32 v130, v212, v213
    v_cvt_pk_bf16_f32 v131, v214, v215
    s_nop 4
    s_branch L_att_join
L_hi_waves:
    v_subrev_u32 v15, 6144, v15
    ds_read_b128 v[120:123], v15
    ds_read_b128 v[124:127], v15 offset:1024
    ds_read_b128 v[128:131], v15 offset:2048
    s_waitcnt lgkmcnt(0)
L_att_join:
    v_mov_b32 v128, 0
    v_mov_b32 v129, 0
    v_mfma_f32_32x32x16_bf16 v[48:63], v[120:123], v[96:99], 0
    v_mfma_f32_32x32x16_bf16 v[64:79], v[124:127], v[100:103], 0
    v_mov_b32 v148, 0xcf6e6b28
    s_mov_b32 s21, 0x3eb8aa3b
    s_nop 8
    v_cndmask_b32 v152, v60, v148, s[24:25]
    v_cndmask_b32 v153, v61, v148, s[24:25]
    v_cndmask_b32 v154, v62, v148, s[24:25]
    v_cndmask_b32 v155, v63, v148, s[24:25]
    v_cndmask_b32 v152, v152, v16, s[60:61]
    v_cndmask_b32 v153, v153, v17, s[62:63]
    v_cndmask_b32 v154, v154, v18, s[64:65]
    s_add_u32 m0, s99, 0x9800
    s_add_u32 s20, s97, 0x81000
    buffer_load_dwordx4 v4, s[44:47], s20 offen lds
    v_cndmask_b32 v155, v155, v19, s[66:67]
    v_cndmask_b32 v152, v152, v20, s[68:69]
    v_cndmask_b32 v153, v153, v21, s[70:71]
    v_cndmask_b32 v154, v154, v22, s[72:73]
    s_nop 0
    s_cbranch_execz L_disp
    v_cndmask_b32 v155, v155, v23, s[74:75]
    v_cndmask_b32 v152, v152, v24, s[76:77]
    v_cndmask_b32 v153, v153, v25, s[78:79]
    v_cndmask_b32 v154, v154, v26, s[80:81]
    v_cndmask_b32 v155, v155, v27, s[82:83]
    v_cndmask_b32 v152, v152, v28, s[84:85]
    v_cndmask_b32 v153, v153, v29, s[86:87]
    v_cndmask_b32 v154, v154, v30, s[88:89]
    v_cndmask_b32 v155, v155, v31, s[90:91]
    s_add_u32 m0, s99, 0x9c00
    s_add_u32 s20, s98, 0x8bc00
    buffer_load_dwordx4 v4, s[44:47], s20 offen lds
    v_cndmask_b32 v160, v76, v148, s[24:25]
    v_cndmask_b32 v161, v77, v148, s[24:25]
    v_cndmask_b32 v162, v78, v148, s[24:25]
    v_cndmask_b32 v163, v79, v148, s[24:25]
    v_cndmask_b32 v160, v160, v32, s[60:61]
    v_cndmask_b32 v161, v161, v33, s[62:63]
    v_cndmask_b32 v162, v162, v34, s[64:65]
    v_cndmask_b32 v163, v163, v35, s[66:67]
    v_cndmask_b32 v160, v160, v36, s[68:69]
    v_cndmask_b32 v161, v161, v37, s[70:71]
    v_cndmask_b32 v162, v162, v38, s[72:73]
    v_cndmask_b32 v163, v163, v39, s[74:75]
    v_cndmask_b32 v160, v160, v40, s[76:77]
    s_add_u32 m0, s99, 0xa000
    s_add_u32 s20, s98, 0x8bc40
    buffer_load_dwordx4 v4, s[44:47], s20 offen lds
    v_cndmask_b32 v161, v161, v41, s[78:79]
    v_cndmask_b32 v162, v162, v42, s[80:81]
    v_cndmask_b32 v163, v163, v43, s[82:83]
    s_nop 0
    s_cbranch_execz L_disp
    v_cndmask_b32 v160, v160, v44, s[84:85]
    v_cndmask_b32 v161, v161, v45, s[86:87]
    v_cndmask_b32 v162, v162, v46, s[88:89]
    v_cndmask_b32 v163, v163, v47, s[90:91]
    v_max3_f32 v156, v152, v153, v154
    v_max_f32 v156, v156, v155
    v_mov_b32 v157, v156
    v_max3_f32 v164, v160, v161, v162
    v_max_f32 v164, v164, v163
    v_mov_b32 v165, v164
    s_add_u32 m0, s99, 0xa400
    s_add_u32 s20, s97, 0x8bc00
    buffer_load_dwordx4 v4, s[44:47], s20 offen lds
    v_permlane32_swap_b32 v156, v157
    v_permlane32_swap_b32 v164, v165
    v_max_f32 v156, v156, v157
    v_mul_f32 v156, s21, v156
    v_fma_f32 v152, v152, s21, -v156
    v_fma_f32 v153, v153, s21, -v156
    v_fma_f32 v154, v154, s21, -v156
    v_fma_f32 v155, v155, s21, -v156
    v_exp_f32 v152, v152
    v_exp_f32 v153, v153
    v_exp_f32 v154, v154
    v_exp_f32 v155, v155
    v_max_f32 v164, v164, v165
    s_add_u32 m0, s99, 0xa800
    s_add_u32 s20, s98, 0x96800
    buffer_load_dwordx4 v4, s[44:47], s20 offen lds
    v_mul_f32 v164, s21, v164
    v_fma_f32 v160, v160, s21, -v164
    v_fma_f32 v161, v161, s21, -v164
    v_fma_f32 v162, v162, s21, -v164
    v_fma_f32 v163, v163, s21, -v164
    v_exp_f32 v160, v160
    v_exp_f32 v161, v161
    v_exp_f32 v162, v162
    v_exp_f32 v163, v163
    v_add_f32 v156, v152, v153
    v_add_f32 v157, v154, v155
    v_add_f32 v156, v156, v157
    v_mov_b32 v157, v156
    s_nop 0
    s_cbranch_execz L_disp
    s_add_u32 m0, s99, 0xac00
    s_add_u32 s20, s98, 0x96840
    buffer_load_dwordx4 v4, s[44:47], s20 offen lds
    v_add_f32 v164, v160, v161
    v_add_f32 v165, v162, v163
    v_add_f32 v164, v164, v165
    v_mov_b32 v165, v164
    v_permlane32_swap_b32 v156, v157
    s_nop 0
    v_permlane32_swap_b32 v164, v165
    v_add_f32 v156, v156, v157
    v_rcp_f32 v156, v156
    s_nop 0
    v_mul_f32 v152, v152, v156
    v_mul_f32 v153, v153, v156
    v_mul_f32 v154, v154, v156
    v_mul_f32 v155, v155, v156
    v_cvt_pk_bf16_f32 v158, v152, v153
    s_add_u32 m0, s99, 0xb000
    s_add_u32 s20, s97, 0x96800
    buffer_load_dwordx4 v4, s[44:47], s20 offen lds
    v_cvt_pk_bf16_f32 v159, v154, v155
    v_mov_b32 v168, 0
    v_mov_b32 v169, 0
    v_and_b32 v170, v158, v240
    v_and_b32 v171, v159, v241
    v_and_b32 v172, v158, v242
    v_and_b32 v173, v159, v243
    v_and_b32 v174, v158, v244
    v_and_b32 v175, v159, v245
    v_and_b32 v176, v158, v246
    v_and_b32 v177, v159, v247
    v_and_b32 v178, v158, v248
    v_and_b32 v179, v159, v249
    s_add_u32 m0, s99, 0xb400
    s_add_u32 s20, s98, 0xa1400
    buffer_load_dwordx4 v4, s[44:47], s20 offen lds
    v_add_f32 v164, v164, v165
    v_rcp_f32 v164, v164
    s_nop 0
    v_mul_f32 v160, v160, v164
    v_mul_f32 v161, v161, v164
    v_mul_f32 v162, v162, v164
    v_mul_f32 v163, v163, v164
    v_cvt_pk_bf16_f32 v166, v160, v161
    v_cvt_pk_bf16_f32 v167, v162, v163
    v_mov_b32 v184, 0
    v_mov_b32 v185, 0
    v_and_b32 v186, v166, v240
    v_and_b32 v187, v167, v241
    s_cbranch_execz L_disp
    v_and_b32 v188, v166, v242
    s_add_u32 m0, s99, 0xb800
    s_add_u32 s20, s98, 0xa1440
    buffer_load_dwordx4 v4, s[44:47], s20 offen lds
    v_and_b32 v189, v167, v243
    v_and_b32 v190, v166, v244
    v_and_b32 v191, v167, v245
    v_and_b32 v192, v166, v246
    v_and_b32 v193, v167, v247
    v_and_b32 v194, v166, v248
    v_and_b32 v195, v167, v249
    v_mfma_f32_32x32x16_bf16 v[80:95], v[128:131], v[168:171], 0
    v_mfma_f32_32x32x16_bf16 v[80:95], v[112:115], v[172:175], v[80:95]
    v_mfma_f32_32x32x16_bf16 v[80:95], v[116:119], v[176:179], v[80:95]
    v_mfma_f32_32x32x16_bf16 v[132:147], v[128:131], v[184:187], 0
    v_mfma_f32_32x32x16_bf16 v[132:147], v[112:115], v[188:191], v[132:147]
    v_mfma_f32_32x32x16_bf16 v[132:147], v[116:119], v[192:195], v[132:147]
    s_add_u32 m0, s99, 0xbc00
    s_add_u32 s20, s97, 0xa1400
    buffer_load_dwordx4 v4, s[44:47], s20 offen lds
    s_add_u32 m0, s99, 0xc000
    s_add_u32 s20, s98, 0xac000
    buffer_load_dwordx4 v4, s[44:47], s20 offen lds
    s_add_u32 m0, s99, 0xc400
    s_add_u32 s20, s98, 0xac040
    buffer_load_dwordx4 v4, s[44:47], s20 offen lds
    s_add_u32 m0, s99, 0xc800
    s_add_u32 s20, s97, 0xac000
    buffer_load_dwordx4 v4, s[44:47], s20 offen lds
    s_lshl_b32 s21, s9, 15
    s_lshl_b32 s22, s8, 11
    s_add_u32 s21, s21, s22
    s_add_u32 s21, s21, 0x400000
    v_cvt_pk_bf16_f32 v200, v80, v81
    v_cvt_pk_bf16_f32 v201, v82, v83
    v_cvt_pk_bf16_f32 v202, v84, v85
    v_cvt_pk_bf16_f32 v203, v86, v87
    s_cbranch_execz L_disp
    buffer_store_dwordx4 v[200:203], v2, s[28:31], s21 offen offset:0 sc1
    v_cvt_pk_bf16_f32 v204, v140, v141
    v_cvt_pk_bf16_f32 v205, v142, v143
    v_cvt_pk_bf16_f32 v206, v144, v145
    v_cvt_pk_bf16_f32 v207, v146, v147
    buffer_store_dwordx4 v[204:207], v2, s[28:31], s21 offen offset:1024 sc1
    s_lshl_b32 s21, s9, 7
    s_lshl_b32 s22, s8, 2
    s_add_u32 s21, s21, s22
    s_add_u32 s21, s21, 0x2000
    ds_read_b64_tr_b16 a[0:1], v10 offset:0
    ds_read_b64_tr_b16 a[2:3], v10 offset:256
    ds_read_b64_tr_b16 a[64:65], v11 offset:0
    ds_read_b64_tr_b16 a[66:67], v11 offset:256
    ds_read_b64_tr_b16 a[4:5], v10 offset:1024
    ds_read_b64_tr_b16 a[6:7], v10 offset:1280
    ds_read_b64_tr_b16 a[68:69], v11 offset:1024
    ds_read_b64_tr_b16 a[70:71], v11 offset:1280
    ds_read_b64_tr_b16 a[8:9], v10 offset:2048
    ds_read_b64_tr_b16 a[10:11], v10 offset:2304
    ds_read_b64_tr_b16 a[72:73], v11 offset:2048
    ds_read_b64_tr_b16 a[74:75], v11 offset:2304
    ds_read_b64_tr_b16 a[12:13], v10 offset:3072
    ds_read_b64_tr_b16 a[14:15], v10 offset:3328
    ds_read_b64_tr_b16 a[76:77], v11 offset:3072
    ds_read_b64_tr_b16 a[78:79], v11 offset:3328
    ds_read_b64_tr_b16 a[16:17], v10 offset:4096
    ds_read_b64_tr_b16 a[18:19], v10 offset:4352
    ds_read_b64_tr_b16 a[80:81], v11 offset:4096
    ds_read_b64_tr_b16 a[82:83], v11 offset:4352
    ds_read_b64_tr_b16 a[20:21], v10 offset:5120
    ds_read_b64_tr_b16 a[22:23], v10 offset:5376
    ds_read_b64_tr_b16 a[84:85], v11 offset:5120
    s_cbranch_execz L_disp
    ds_read_b64_tr_b16 a[86:87], v11 offset:5376
    ds_read_b64_tr_b16 a[24:25], v10 offset:6144
    ds_read_b64_tr_b16 a[26:27], v10 offset:6400
    ds_read_b64_tr_b16 a[88:89], v11 offset:6144
    ds_read_b64_tr_b16 a[90:91], v11 offset:6400
    ds_read_b64_tr_b16 a[28:29], v10 offset:7168
    ds_read_b64_tr_b16 a[30:31], v10 offset:7424
    ds_read_b64_tr_b16 a[92:93], v12 offset:0
    ds_read_b64_tr_b16 a[94:95], v12 offset:256
    ds_read_b64_tr_b16 a[32:33], v10 offset:8192
    ds_read_b64_tr_b16 a[34:35], v10 offset:8448
    ds_read_b64_tr_b16 a[96:97], v11 offset:7168
    ds_read_b64_tr_b16 a[98:99], v11 offset:7424
    ds_read_b64_tr_b16 a[36:37], v10 offset:9216
    ds_read_b64_tr_b16 a[38:39], v10 offset:9472
    ds_read_b64_tr_b16 a[100:101], v11 offset:8192
    ds_read_b64_tr_b16 a[102:103], v11 offset:8448
    ds_read_b64_tr_b16 a[40:41], v10 offset:10240
    ds_read_b64_tr_b16 a[42:43], v10 offset:10496
    ds_read_b64_tr_b16 a[104:105], v11 offset:9216
    ds_read_b64_tr_b16 a[106:107], v11 offset:9472
    ds_read_b64_tr_b16 a[44:45], v10 offset:11264
    ds_read_b64_tr_b16 a[46:47], v10 offset:11520
    ds_read_b64_tr_b16 a[108:109], v11 offset:10240
    ds_read_b64_tr_b16 a[110:111], v11 offset:10496
    ds_read_b64_tr_b16 a[48:49], v10 offset:12288
    ds_read_b64_tr_b16 a[50:51], v10 offset:12544
    ds_read_b64_tr_b16 a[112:113], v11 offset:11264
    ds_read_b64_tr_b16 a[114:115], v11 offset:11520
    ds_read_b64_tr_b16 a[52:53], v10 offset:13312
    ds_read_b64_tr_b16 a[54:55], v10 offset:13568
    s_nop 0
    s_cbranch_execz L_disp
    ds_read_b64_tr_b16 a[116:117], v11 offset:12288
    ds_read_b64_tr_b16 a[118:119], v11 offset:12544
    ds_read_b64_tr_b16 a[56:57], v10 offset:14336
    ds_read_b64_tr_b16 a[58:59], v10 offset:14592
    ds_read_b64_tr_b16 a[120:121], v11 offset:13312
    ds_read_b64_tr_b16 a[122:123], v11 offset:13568
    ds_read_b64_tr_b16 a[60:61], v10 offset:15360
    ds_read_b64_tr_b16 a[62:63], v10 offset:15616
    ds_read_b64_tr_b16 a[124:125], v12 offset:1024
    ds_read_b64_tr_b16 a[126:127], v12 offset:1280
    s_mul_i32 s55, s3, 21
    s_min_u32 s54, s3, 2
    s_add_u32 s55, s55, s54
    s_lshl_b32 s54, s55, 14
    s_mul_i32 s26, s5, 3072
    s_add_u32 s26, s26, s54
    s_lshl_b32 s27, s5, 13
    s_add_u32 s57, s54, s27
    s_add_u32 s57, s57, 98304
    s_lshl_b32 s27, s11, 7
    s_add_u32 s54, s54, s27
    s_mul_i32 s56, s3, 12288
    v_lshlrev_b32 v14, 7, v1
    v_and_b32 v5, 31, v1
    v_lshrrev_b32 v6, 5, v1
    v_lshlrev_b32 v7, 11, v5
    v_lshl_add_u32 v7, v6, 4, v7
    v_lshlrev_b32 v6, 5, v6
    s_lshr_b32 s52, s14, 1
    s_lshl_b32 s52, s52, 16
    s_lshl_b32 s53, s12, 10
    s_add_u32 s52, s52, s53
    s_lshl_b32 s53, s15, 6
    s_add_u32 s52, s52, s53
    s_lshl_b32 s53, s15, 7
    s_add_u32 s53, s53, 0x1c000
    s_waitcnt vmcnt(0)
    s_mov_b64 exec, 1
    buffer_store_dword v254, off, s[28:31], s21
    s_add_u32 s21, s21, 0x8000
    buffer_store_dword v254, off, s[28:31], s21 sc1
    s_mov_b64 exec, -1
    s_mul_i32 s99, s3, 88064
    s_sub_u32 s98, s98, s99
    s_cbranch_execz L_disp
    s_sub_u32 s97, s97, s99
    s_mul_i32 s99, s3, 9216
    v_lshlrev_b32 v15, 2, v1
    s_lshl_b32 s21, s14, 7
    s_lshl_b32 s22, s13, 5
    s_add_u32 s21, s21, s22
    s_add_u32 s21, s21, 0x2000
    s_lshl_b32 s26, s14, 15
    s_lshl_b32 s27, s13, 14
    s_add_u32 s26, s26, s27
    s_add_u32 s26, s26, 0x400000
    s_mov_b32 exec_lo, 0xff
    s_mov_b32 exec_hi, 0
    s_mov_b32 s17, 0
    s_add_u32 s18, s21, 0x8000
    s_cmp_eq_u32 s16, 0
    s_nop 0
    s_cbranch_scc1 ps_10
pf_9:
    buffer_load_dword v32, v15, s[28:31], s21 offen sc1
    s_add_u32 s17, s17, 1
    s_waitcnt vmcnt(0)
    v_cmp_ne_u32 vcc, s6, v32
    s_nop 4
    s_cbranch_vccz pd_11
    s_cmp_lt_u32 s17, s16
    s_cbranch_scc1 pf_9
ps_10:
    buffer_load_dword v32, v15, s[28:31], s21 offen sc1
    buffer_load_dword v33, v15, s[28:31], s18 offen sc1
    s_add_u32 s17, s17, 1
    s_waitcnt vmcnt(0)
    v_cmp_ne_u32 s[22:23], s6, v32
    v_cmp_ne_u32 vcc, s6, v33
    s_nop 4
    s_and_b64 vcc, vcc, s[22:23]
    s_cmp_eq_u64 vcc, 0
    s_cbranch_scc1 pd_11
    s_cmp_lt_u32 s17, 30000
    s_cbranch_scc1 ps_10
pd_11:
    s_mov_b64 exec, -1
    buffer_load_dwordx4 v[64:67], v2, s[28:31], s26 offen offset:0 sc1
    buffer_load_dwordx4 v[68:71], v2, s[28:31], s26 offen offset:1024 sc1
    buffer_load_dwordx4 v[72:75], v2, s[28:31], s26 offen offset:2048 sc1
    buffer_load_dwordx4 v[76:79], v2, s[28:31], s26 offen offset:3072 sc1
    s_add_u32 s26, s26, 4096
    buffer_load_dwordx4 v[80:83], v2, s[28:31], s26 offen offset:0 sc1
    buffer_load_dwordx4 v[84:87], v2, s[28:31], s26 offen offset:1024 sc1
    s_cbranch_execz L_disp
    buffer_load_dwordx4 v[88:91], v2, s[28:31], s26 offen offset:2048 sc1
    buffer_load_dwordx4 v[92:95], v2, s[28:31], s26 offen offset:3072 sc1
    s_add_u32 s26, s26, 4096
    buffer_load_dwordx4 v[96:99], v2, s[28:31], s26 offen offset:0 sc1
    buffer_load_dwordx4 v[100:103], v2, s[28:31], s26 offen offset:1024 sc1
    s_lshl_b32 s19, s3, 9
    s_add_u32 s19, s19, 159744
    v_add_u32 v187, s19, v6
    s_waitcnt lgkmcnt(0)
    s_barrier
    v_accvgpr_read_b32 v8, a160
    v_accvgpr_read_b32 v128, a164
    v_accvgpr_read_b32 v9, a161
    v_accvgpr_read_b32 v129, a165
    v_accvgpr_read_b32 v10, a162
    v_accvgpr_read_b32 v130, a166
    v_accvgpr_read_b32 v11, a163
    v_accvgpr_read_b32 v131, a167
    v_lshlrev_b32 v160, 16, v8
    v_and_b32 v161, 0xffff0000, v8
    v_lshlrev_b32 v162, 16, v9
    v_and_b32 v163, 0xffff0000, v9
    v_lshlrev_b32 v164, 16, v10
    v_and_b32 v165, 0xffff0000, v10
    v_lshlrev_b32 v166, 16, v11
    v_and_b32 v167, 0xffff0000, v11
    v_lshlrev_b32 v168, 16, v128
    v_and_b32 v169, 0xffff0000, v128
    v_lshlrev_b32 v170, 16, v129
    v_and_b32 v171, 0xffff0000, v129
    v_lshlrev_b32 v172, 16, v130
    v_and_b32 v173, 0xffff0000, v130
    v_lshlrev_b32 v174, 16, v131
    v_and_b32 v175, 0xffff0000, v131
    ds_read_b128 v[16:19], v187 offset:0
    ds_read_b128 v[132:135], v187 offset:128
    ds_read_b128 a[224:227], v187 offset:256
    s_nop 0
    s_cbranch_execz L_disp
    ds_read_b128 v[20:23], v187 offset:16
    ds_read_b128 v[136:139], v187 offset:144
    ds_read_b128 a[228:231], v187 offset:272
    ds_read_b128 v[24:27], v187 offset:64
    ds_read_b128 v[140:143], v187 offset:192
    ds_read_b128 a[232:235], v187 offset:320
    ds_read_b128 v[28:31], v187 offset:80
    ds_read_b128 v[144:147], v187 offset:208
    ds_read_b128 a[236:239], v187 offset:336
    s_lshl_b32 s27, s3, 12
    s_add_u32 s27, s27, 98304
    v_add_u32 v15, s27, v2
    s_waitcnt vmcnt(9)
    v_mfma_f32_32x32x16_bf16 v[32:47], a[0:3], v[64:67], 0
    buffer_load_dwordx4 v[104:107], v2, s[28:31], s26 offen offset:2048 sc1
    v_mfma_f32_32x32x16_bf16 v[48:63], a[64:67], v[64:67], 0
    s_waitcnt vmcnt(9)
    v_mfma_f32_32x32x16_bf16 v[32:47], a[4:7], v[68:71], v[32:47]
    buffer_load_dwordx4 v[108:111], v2, s[28:31], s26 offen offset:3072 sc1
    v_mfma_f32_32x32x16_bf16 v[48:63], a[68:71], v[68:71], v[48:63]
    s_waitcnt vmcnt(9)
    v_mfma_f32_32x32x16_bf16 v[32:47], a[8:11], v[72:75], v[32:47]
    s_add_u32 s26, s26, 4096
    buffer_load_dwordx4 v[112:115], v2, s[28:31], s26 offen offset:0 sc1
    v_mfma_f32_32x32x16_bf16 v[48:63], a[72:75], v[72:75], v[48:63]
    s_add_u32 m0, s99, 0x0
    s_add_u32 s20, s98, 0x0
    buffer_load_dwordx4 v4, s[44:47], s20 offen lds
    s_waitcnt vmcnt(10)
    v_mfma_f32_32x32x16_bf16 v[32:47], a[12:15], v[76:79], v[32:47]
    buffer_load_dwordx4 v[116:119], v2, s[28:31], s26 offen offset:1024 sc1
    v_mfma_f32_32x32x16_bf16 v[48:63], a[76:79], v[76:79], v[48:63]
    s_add_u32 m0, s99, 0x400
    s_add_u32 s20, s98, 0x40
    buffer_load_dwordx4 v4, s[44:47], s20 offen lds
    s_waitcnt vmcnt(11)
    s_nop 0
    s_cbranch_execz L_disp
    v_mfma_f32_32x32x16_bf16 v[32:47], a[16:19], v[80:83], v[32:47]
    buffer_load_dwordx4 v[120:123], v2, s[28:31], s26 offen offset:2048 sc1
    v_mfma_f32_32x32x16_bf16 v[48:63], a[80:83], v[80:83], v[48:63]
    s_add_u32 m0, s99, 0x800
    s_add_u32 s20, s97, 0x0
    buffer_load_dwordx4 v4, s[44:47], s20 offen lds
    s_waitcnt vmcnt(12)
    v_mfma_f32_32x32x16_bf16 v[32:47], a[20:23], v[84:87], v[32:47]
    buffer_load_dwordx4 v[124:127], v2, s[28:31], s26 offen offset:3072 sc1
    v_mfma_f32_32x32x16_bf16 v[48:63], a[84:87], v[84:87], v[48:63]
    s_add_u32 m0, s99, 0xc00
    s_add_u32 s20, s98, 0xac00
    buffer_load_dwordx4 v4, s[44:47], s20 offen lds
    s_waitcnt vmcnt(13)
    v_mfma_f32_32x32x16_bf16 v[32:47], a[24:27], v[88:91], v[32:47]
    v_mfma_f32_32x32x16_bf16 v[48:63], a[88:91], v[88:91], v[48:63]
    s_add_u32 m0, s99, 0x1000
    s_add_u32 s20, s98, 0xac40
    buffer_load_dwordx4 v4, s[44:47], s20 offen lds
    s_waitcnt vmcnt(13)
    v_mfma_f32_32x32x16_bf16 v[32:47], a[28:31], v[92:95], v[32:47]
    v_mfma_f32_32x32x16_bf16 v[48:63], a[92:95], v[92:95], v[48:63]
    s_add_u32 m0, s99, 0x1400
    s_add_u32 s20, s97, 0xac00
    buffer_load_dwordx4 v4, s[44:47], s20 offen lds
    s_waitcnt vmcnt(13)
    v_mfma_f32_32x32x16_bf16 v[32:47], a[32:35], v[96:99], v[32:47]
    v_mfma_f32_32x32x16_bf16 v[48:63], a[96:99], v[96:99], v[48:63]
    s_add_u32 m0, s99, 0x1800
    s_add_u32 s20, s98, 0x15800
    buffer_load_dwordx4 v4, s[44:47], s20 offen lds
    s_waitcnt vmcnt(13)
    v_mfma_f32_32x32x16_bf16 v[32:47], a[36:39], v[100:103], v[32:47]
    v_mfma_f32_32x32x16_bf16 v[48:63], a[100:103], v[100:103], v[48:63]
    s_nop 0
    s_cbranch_execz L_disp
    s_add_u32 m0, s99, 0x1c00
    s_add_u32 s20, s98, 0x15840
    buffer_load_dwordx4 v4, s[44:47], s20 offen lds
    s_waitcnt vmcnt(13)
    v_mfma_f32_32x32x16_bf16 v[32:47], a[40:43], v[104:107], v[32:47]
    v_mfma_f32_32x32x16_bf16 v[48:63], a[104:107], v[104:107], v[48:63]
    s_add_u32 m0, s99, 0x2000
    s_add_u32 s20, s97, 0x15800
    buffer_load_dwordx4 v4, s[44:47], s20 offen lds
    s_waitcnt vmcnt(13)
    v_mfma_f32_32x32x16_bf16 v[32:47], a[44:47], v[108:111], v[32:47]
    v_mfma_f32_32x32x16_bf16 v[48:63], a[108:111], v[108:111], v[48:63]
    s_waitcnt vmcnt(12)
    v_mfma_f32_32x32x16_bf16 v[32:47], a[48:51], v[112:115], v[32:47]
    v_mfma_f32_32x32x16_bf16 v[48:63], a[112:115], v[112:115], v[48:63]
    s_waitcnt vmcnt(10)
    v_mfma_f32_32x32x16_bf16 v[32:47], a[52:55], v[116:119], v[32:47]
    v_mfma_f32_32x32x16_bf16 v[48:63], a[116:119], v[116:119], v[48:63]
    s_waitcnt vmcnt(8)
    v_mfma_f32_32x32x16_bf16 v[32:47], a[56:59], v[120:123], v[32:47]
    v_mfma_f32_32x32x16_bf16 v[48:63], a[120:123], v[120:123], v[48:63]
    s_waitcnt vmcnt(6)
    v_mfma_f32_32x32x16_bf16 v[32:47], a[60:63], v[124:127], v[32:47]
    v_mfma_f32_32x32x16_bf16 v[48:63], a[124:127], v[124:127], v[48:63]
    s_cmp_eq_u32 s13, 0
    s_nop 10
    s_cbranch_scc1 L_kh0
    ds_write_b128 v15, v[32:35] offset:0
    ds_write_b128 v15, v[36:39] offset:1024
    ds_write_b128 v15, v[40:43] offset:2048
    ds_write_b128 v15, v[44:47] offset:3072
    v_mov_b32 v32, v48
    v_mov_b32 v33, v49
    v_mov_b32 v34, v50
    v_mov_b32 v35, v51
    v_mov_b32 v36, v52
    v_mov_b32 v37, v53
    v_mov_b32 v38, v54
    v_mov_b32 v39, v55
    v_mov_b32 v40, v56
    v_mov_b32 v41, v57
    s_cbranch_execz L_disp
    v_mov_b32 v42, v58
    v_mov_b32 v43, v59
    v_mov_b32 v44, v60
    v_mov_b32 v45, v61
    v_mov_b32 v46, v62
    v_mov_b32 v47, v63
    s_nop 4
    s_branch L_kh_j
L_kh0:
    ds_write_b128 v15, v[48:51] offset:0
    ds_write_b128 v15, v[52:55] offset:1024
    ds_write_b128 v15, v[56:59] offset:2048
    ds_write_b128 v15, v[60:63] offset:3072
L_kh_j:
    s_lshl_b32 s26, s14, 15
    s_lshl_b32 s27, s15, 11
    s_add_u32 s26, s26, s27
    s_add_u32 s26, s26, 0x600000
    s_lshl_b32 s21, s14, 12
    s_lshl_b32 s27, s15, 8
    s_add_u32 s21, s21, s27
    s_add_u32 s21, s21, 0x40000
    v_mov_b32 v80, 0x3f803f80
    v_lshlrev_b32 v81, 3, v5
    s_waitcnt vmcnt(0)
    s_waitcnt lgkmcnt(0)
    s_barrier
    v_xor_b32 v15, 0x2000, v15
    ds_read_b128 v[64:67], v15 offset:0
    ds_read_b128 v[68:71], v15 offset:1024
    ds_read_b128 v[72:75], v15 offset:2048
    ds_read_b128 v[76:79], v15 offset:3072
    s_waitcnt lgkmcnt(3)
    s_add_u32 m0, s56, 0x1c000
    s_add_u32 s20, s54, 0x0
    buffer_load_dwordx4 v3, s[48:51], s20 offen lds
    v_add_f32 v32, v32, v64
    v_add_f32 v33, v33, v65
    v_add_f32 v34, v34, v66
    v_add_f32 v35, v35, v67
    v_fma_f32 v32, v32, v16, v160
    v_fma_f32 v33, v33, v17, v161
    v_fma_f32 v34, v34, v18, v162
    v_fma_f32 v35, v35, v19, v163
    s_waitcnt lgkmcnt(2)
    v_add_f32 v36, v36, v68
    v_add_f32 v37, v37, v69
    s_cbranch_execz L_disp
    s_add_u32 m0, s56, 0x1d800
    s_add_u32 s20, s54, 0x40
    buffer_load_dwordx4 v3, s[48:51], s20 offen lds
    v_add_f32 v38, v38, v70
    v_add_f32 v39, v39, v71
    v_fma_f32 v36, v36, v20, v164
    v_fma_f32 v37, v37, v21, v165
    v_fma_f32 v38, v38, v22, v166
    v_fma_f32 v39, v39, v23, v167
    s_waitcnt lgkmcnt(1)
    v_add_f32 v40, v40, v72
    v_add_f32 v41, v41, v73
    v_add_f32 v42, v42, v74
    v_add_f32 v43, v43, v75
    s_add_u32 m0, s56, 0x1c400
    s_add_u32 s20, s54, 0x4000
    buffer_load_dwordx4 v3, s[48:51], s20 offen lds
    v_fma_f32 v40, v40, v24, v168
    v_fma_f32 v41, v41, v25, v169
    v_fma_f32 v42, v42, v26, v170
    v_fma_f32 v43, v43, v27, v171
    s_waitcnt lgkmcnt(0)
    v_add_f32 v44, v44, v76
    v_add_f32 v45, v45, v77
    v_add_f32 v46, v46, v78
    v_add_f32 v47, v47, v79
    v_fma_f32 v44, v44, v28, v172
    v_fma_f32 v45, v45, v29, v173
    s_add_u32 m0, s56, 0x1dc00
    s_add_u32 s20, s54, 0x4040
    buffer_load_dwordx4 v3, s[48:51], s20 offen lds
    v_fma_f32 v46, v46, v30, v174
    v_fma_f32 v47, v47, v31, v175
    ds_write_b128 v15, a[168:171]
    ds_write_b128 v15, a[172:175] offset:1024
    v_cvt_pk_bf16_f32 v244, v32, v33
    v_cvt_pk_bf16_f32 v245, v34, v35
    v_cvt_pk_bf16_f32 v246, v36, v37
    s_cbranch_execz L_disp
    v_cvt_pk_bf16_f32 v247, v38, v39
    v_cvt_pk_bf16_f32 v248, v40, v41
    v_cvt_pk_bf16_f32 v249, v42, v43
    v_cvt_pk_bf16_f32 v250, v44, v45
    s_add_u32 m0, s56, 0x1c800
    s_add_u32 s20, s54, 0x8000
    buffer_load_dwordx4 v3, s[48:51], s20 offen lds
    v_cvt_pk_bf16_f32 v251, v46, v47
    v_lshlrev_b32 v32, 16, v244
    v_and_b32 v33, 0xffff0000, v244
    v_lshlrev_b32 v34, 16, v245
    v_and_b32 v35, 0xffff0000, v245
    v_lshlrev_b32 v36, 16, v246
    v_and_b32 v37, 0xffff0000, v246
    v_lshlrev_b32 v38, 16, v247
    v_and_b32 v39, 0xffff0000, v247
    v_lshlrev_b32 v40, 16, v248
    v_and_b32 v41, 0xffff0000, v248
    s_add_u32 m0, s56, 0x1e000
    s_add_u32 s20, s54, 0x8040
    buffer_load_dwordx4 v3, s[48:51], s20 offen lds
    v_lshlrev_b32 v42, 16, v249
    v_and_b32 v43, 0xffff0000, v249
    v_lshlrev_b32 v44, 16, v250
    v_and_b32 v45, 0xffff0000, v250
    v_lshlrev_b32 v46, 16, v251
    v_and_b32 v47, 0xffff0000, v251
    v_pk_mul_f32 v[32:33], v[32:33], v[132:133]
    v_pk_mul_f32 v[34:35], v[34:35], v[134:135]
    v_pk_mul_f32 v[36:37], v[36:37], v[136:137]
    v_pk_mul_f32 v[38:39], v[38:39], v[138:139]
    v_pk_mul_f32 v[40:41], v[40:41], v[140:141]
    v_pk_mul_f32 v[42:43], v[42:43], v[142:143]
    v_pk_mul_f32 v[44:45], v[44:45], v[144:145]
    v_pk_mul_f32 v[46:47], v[46:47], v[146:147]
    s_nop 0
    s_cbranch_execz L_disp
    v_cvt_pk_bf16_f32 v64, v32, v33
    v_cvt_pk_bf16_f32 v65, v34, v35
    v_cvt_pk_bf16_f32 v66, v36, v37
    v_cvt_pk_bf16_f32 v67, v38, v39
    v_cvt_pk_bf16_f32 v68, v40, v41
    v_cvt_pk_bf16_f32 v69, v42, v43
    v_cvt_pk_bf16_f32 v70, v44, v45
    v_cvt_pk_bf16_f32 v71, v46, v47
    buffer_store_dwordx4 v[64:67], v2, s[28:31], s26 offen sc1
    buffer_store_dwordx4 v[68:71], v2, s[28:31], s26 offen offset:1024 sc1
    v_dot2_f32_bf16 v82, v244, v80, 0
    v_dot2_f32_bf16 v83, v244, v244, 0
    v_dot2_f32_bf16 v84, v245, v80, 0
    v_dot2_f32_bf16 v85, v245, v245, 0
    v_dot2c_f32_bf16 v82, v246, v80
    v_dot2c_f32_bf16 v83, v246, v246
    v_dot2c_f32_bf16 v84, v247, v80
    v_dot2c_f32_bf16 v85, v247, v247
    v_dot2c_f32_bf16 v82, v248, v80
    v_dot2c_f32_bf16 v83, v248, v248
    v_dot2c_f32_bf16 v84, v249, v80
    v_dot2c_f32_bf16 v85, v249, v249
    v_dot2c_f32_bf16 v82, v250, v80
    v_dot2c_f32_bf16 v83, v250, v250
    v_dot2c_f32_bf16 v84, v251, v80
    v_dot2c_f32_bf16 v85, v251, v251
    s_nop 1
    v_add_f32 v82, v82, v84
    v_add_f32 v83, v83, v85
    v_mov_b32 v84, v82
    v_mov_b32 v85, v83
    s_nop 0
    v_permlane32_swap_b32 v82, v84
    v_permlane32_swap_b32 v83, v85
    v_add_f32 v82, v82, v84
    v_add_f32 v83, v83, v85
    s_mov_b32 exec_hi, 0
    buffer_store_dwordx2 v[82:83], v81, s[28:31], s21 offen sc1
    s_mov_b32 exec_hi, -1
    s_lshl_b32 s21, s14, 7
    s_lshl_b32 s22, s15, 2
    s_add_u32 s21, s21, s22
    s_add_u32 s21, s21, 0x4000
    s_xor_b32 s26, s3, 2
    s_lshl_b32 s26, s26, 12
    s_add_u32 s26, s26, 98304
    s_cbranch_execz L_disp
    v_add_u32 v9, 49152, v253
    s_lshl_b32 s27, s3, 10
    v_add_u32 v10, s27, v253
    v_add_u32 v8, s27, v9
    v_and_b32 v11, 1, v1
    v_xor_b32 v12, 1, v11
    v_lshlrev_b32 v12, 10, v12
    v_lshrrev_b32 v13, 5, v1
    v_lshl_add_u32 v12, v13, 4, v12
    v_add_u32 v12, s26, v12
    s_cmp_eq_u32 s3, 3
    s_nop 3
    s_cbranch_scc1 L_noub
    ds_read_b64_tr_b16 a[0:1], v10 offset:0
    ds_read_b64_tr_b16 a[2:3], v10 offset:256
    ds_read_b128 a[4:7], v12 offset:0
    ds_read_b64_tr_b16 a[8:9], v10 offset:3072
    ds_read_b64_tr_b16 a[10:11], v10 offset:3328
    ds_read_b128 a[12:15], v12 offset:32
    ds_read_b64_tr_b16 a[16:17], v10 offset:6144
    ds_read_b64_tr_b16 a[18:19], v10 offset:6400
    ds_read_b128 a[20:23], v12 offset:64
    ds_read_b64_tr_b16 a[24:25], v10 offset:9216
    ds_read_b64_tr_b16 a[26:27], v10 offset:9472
    ds_read_b128 a[28:31], v12 offset:96
    s_waitcnt lgkmcnt(9)
    v_mfma_f32_32x32x16_bf16 v[16:31], a[0:3], a[4:7], 0
    ds_read_b64_tr_b16 a[0:1], v10 offset:12288
    ds_read_b64_tr_b16 a[2:3], v10 offset:12544
    ds_read_b128 a[4:7], v12 offset:128
    s_waitcnt lgkmcnt(9)
    v_mfma_f32_32x32x16_bf16 v[16:31], a[8:11], a[12:15], v[16:31]
    ds_read_b64_tr_b16 a[8:9], v10 offset:15360
    ds_read_b64_tr_b16 a[10:11], v10 offset:15616
    ds_read_b128 a[12:15], v12 offset:160
    s_waitcnt lgkmcnt(9)
    v_mfma_f32_32x32x16_bf16 v[16:31], a[16:19], a[20:23], v[16:31]
    ds_read_b64_tr_b16 a[16:17], v10 offset:18432
    s_nop 0
    s_cbranch_execz L_disp
    ds_read_b64_tr_b16 a[18:19], v10 offset:18688
    ds_read_b128 a[20:23], v12 offset:192
    s_waitcnt lgkmcnt(9)
    v_mfma_f32_32x32x16_bf16 v[16:31], a[24:27], a[28:31], v[16:31]
    ds_read_b64_tr_b16 a[24:25], v10 offset:21504
    ds_read_b64_tr_b16 a[26:27], v10 offset:21760
    ds_read_b128 a[28:31], v12 offset:224
    s_waitcnt lgkmcnt(9)
    v_mfma_f32_32x32x16_bf16 v[16:31], a[0:3], a[4:7], v[16:31]
    ds_read_b64_tr_b16 a[0:1], v10 offset:24576
    ds_read_b64_tr_b16 a[2:3], v10 offset:24832
    ds_read_b128 a[4:7], v12 offset:256
    s_waitcnt lgkmcnt(9)
    v_mfma_f32_32x32x16_bf16 v[16:31], a[8:11], a[12:15], v[16:31]
    ds_read_b64_tr_b16 a[8:9], v10 offset:27648
    ds_read_b64_tr_b16 a[10:11], v10 offset:27904
    ds_read_b128 a[12:15], v12 offset:288
    s_waitcnt lgkmcnt(9)
    v_mfma_f32_32x32x16_bf16 v[16:31], a[16:19], a[20:23], v[16:31]
    ds_read_b64_tr_b16 a[16:17], v10 offset:30720
    ds_read_b64_tr_b16 a[18:19], v10 offset:30976
    ds_read_b128 a[20:23], v12 offset:320
    s_waitcnt lgkmcnt(9)
    v_mfma_f32_32x32x16_bf16 v[16:31], a[24:27], a[28:31], v[16:31]
    ds_read_b64_tr_b16 a[24:25], v10 offset:33792
    ds_read_b64_tr_b16 a[26:27], v10 offset:34048
    ds_read_b128 a[28:31], v12 offset:352
    s_waitcnt lgkmcnt(9)
    v_mfma_f32_32x32x16_bf16 v[16:31], a[0:3], a[4:7], v[16:31]
    ds_read_b64_tr_b16 a[0:1], v10 offset:36864
    ds_read_b64_tr_b16 a[2:3], v10 offset:37120
    ds_read_b128 a[4:7], v12 offset:384
    s_waitcnt lgkmcnt(9)
    v_mfma_f32_32x32x16_bf16 v[16:31], a[8:11], a[12:15], v[16:31]
    ds_read_b64_tr_b16 a[8:9], v10 offset:39936
    s_cbranch_execz L_disp
    ds_read_b64_tr_b16 a[10:11], v10 offset:40192
    ds_read_b128 a[12:15], v12 offset:416
    s_waitcnt lgkmcnt(9)
    v_mfma_f32_32x32x16_bf16 v[16:31], a[16:19], a[20:23], v[16:31]
    ds_read_b64_tr_b16 a[16:17], v10 offset:43008
    ds_read_b64_tr_b16 a[18:19], v10 offset:43264
    ds_read_b128 a[20:23], v12 offset:448
    s_waitcnt lgkmcnt(9)
    v_mfma_f32_32x32x16_bf16 v[16:31], a[24:27], a[28:31], v[16:31]
    ds_read_b64_tr_b16 a[24:25], v10 offset:46080
    ds_read_b64_tr_b16 a[26:27], v10 offset:46336
    ds_read_b128 a[28:31], v12 offset:480
    s_waitcnt lgkmcnt(9)
    v_mfma_f32_32x32x16_bf16 v[16:31], a[0:3], a[4:7], v[16:31]
    ds_read_b64_tr_b16 a[0:1], v8 offset:0
    ds_read_b64_tr_b16 a[2:3], v8 offset:256
    ds_read_b128 a[4:7], v12 offset:512
    s_waitcnt lgkmcnt(9)
    v_mfma_f32_32x32x16_bf16 v[16:31], a[8:11], a[12:15], v[16:31]
    ds_read_b64_tr_b16 a[8:9], v8 offset:3072
    ds_read_b64_tr_b16 a[10:11], v8 offset:3328
    ds_read_b128 a[12:15], v12 offset:544
    s_waitcnt lgkmcnt(9)
    v_mfma_f32_32x32x16_bf16 v[16:31], a[16:19], a[20:23], v[16:31]
    ds_read_b64_tr_b16 a[16:17], v8 offset:6144
    ds_read_b64_tr_b16 a[18:19], v8 offset:6400
    ds_read_b128 a[20:23], v12 offset:576
    s_waitcnt lgkmcnt(9)
    v_mfma_f32_32x32x16_bf16 v[16:31], a[24:27], a[28:31], v[16:31]
    ds_read_b64_tr_b16 a[24:25], v8 offset:9216
    ds_read_b64_tr_b16 a[26:27], v8 offset:9472
    ds_read_b128 a[28:31], v12 offset:608
    s_waitcnt lgkmcnt(9)
    v_mfma_f32_32x32x16_bf16 v[16:31], a[0:3], a[4:7], v[16:31]
    s_waitcnt vmcnt(0)
    s_mov_b64 exec, 1
    s_cbranch_execz L_disp
    buffer_store_dword v254, off, s[28:31], s21
    s_add_u32 s21, s21, 0x8000
    buffer_store_dword v254, off, s[28:31], s21 sc1
    s_mov_b64 exec, -1
    ds_read_b64_tr_b16 a[0:1], v8 offset:12288
    ds_read_b64_tr_b16 a[2:3], v8 offset:12544
    ds_read_b128 a[4:7], v12 offset:640
    s_waitcnt lgkmcnt(9)
    v_mfma_f32_32x32x16_bf16 v[16:31], a[8:11], a[12:15], v[16:31]
    ds_read_b64_tr_b16 a[8:9], v8 offset:15360
    ds_read_b64_tr_b16 a[10:11], v8 offset:15616
    ds_read_b128 a[12:15], v12 offset:672
    s_waitcnt lgkmcnt(9)
    v_mfma_f32_32x32x16_bf16 v[16:31], a[16:19], a[20:23], v[16:31]
    s_add_u32 m0, s56, 0x1cc00
    s_add_u32 s20, s54, 0xc000
    buffer_load_dwordx4 v3, s[48:51], s20 offen lds
    ds_read_b64_tr_b16 a[16:17], v8 offset:18432
    ds_read_b64_tr_b16 a[18:19], v8 offset:18688
    ds_read_b128 a[20:23], v12 offset:704
    s_waitcnt lgkmcnt(9)
    v_mfma_f32_32x32x16_bf16 v[16:31], a[24:27], a[28:31], v[16:31]
    ds_read_b64_tr_b16 a[24:25], v8 offset:21504
    ds_read_b64_tr_b16 a[26:27], v8 offset:21760
    ds_read_b128 a[28:31], v12 offset:736
    s_waitcnt lgkmcnt(9)
    v_mfma_f32_32x32x16_bf16 v[16:31], a[0:3], a[4:7], v[16:31]
    s_add_u32 m0, s56, 0x1e400
    s_add_u32 s20, s54, 0xc040
    buffer_load_dwordx4 v3, s[48:51], s20 offen lds
    ds_read_b64_tr_b16 a[0:1], v8 offset:24576
    ds_read_b64_tr_b16 a[2:3], v8 offset:24832
    ds_read_b128 a[4:7], v12 offset:768
    s_waitcnt lgkmcnt(9)
    s_nop 0
    s_cbranch_execz L_disp
    v_mfma_f32_32x32x16_bf16 v[16:31], a[8:11], a[12:15], v[16:31]
    ds_read_b64_tr_b16 a[8:9], v8 offset:27648
    ds_read_b64_tr_b16 a[10:11], v8 offset:27904
    ds_read_b128 a[12:15], v12 offset:800
    s_waitcnt lgkmcnt(9)
    v_mfma_f32_32x32x16_bf16 v[16:31], a[16:19], a[20:23], v[16:31]
    s_add_u32 m0, s56, 0x1d000
    s_add_u32 s20, s54, 0x10000
    buffer_load_dwordx4 v3, s[48:51], s20 offen lds
    ds_read_b64_tr_b16 a[16:17], v8 offset:30720
    ds_read_b64_tr_b16 a[18:19], v8 offset:30976
    ds_read_b128 a[20:23], v12 offset:832
    s_waitcnt lgkmcnt(9)
    v_mfma_f32_32x32x16_bf16 v[16:31], a[24:27], a[28:31], v[16:31]
    ds_read_b64_tr_b16 a[24:25], v8 offset:33792
    ds_read_b64_tr_b16 a[26:27], v8 offset:34048
    ds_read_b128 a[28:31], v12 offset:864
    s_waitcnt lgkmcnt(9)
    v_mfma_f32_32x32x16_bf16 v[16:31], a[0:3], a[4:7], v[16:31]
    s_add_u32 m0, s56, 0x1e800
    s_add_u32 s20, s54, 0x10040
    buffer_load_dwordx4 v3, s[48:51], s20 offen lds
    ds_read_b64_tr_b16 a[0:1], v8 offset:36864
    ds_read_b64_tr_b16 a[2:3], v8 offset:37120
    ds_read_b128 a[4:7], v12 offset:896
    s_waitcnt lgkmcnt(9)
    v_mfma_f32_32x32x16_bf16 v[16:31], a[8:11], a[12:15], v[16:31]
    ds_read_b64_tr_b16 a[8:9], v8 offset:39936
    ds_read_b64_tr_b16 a[10:11], v8 offset:40192
    ds_read_b128 a[12:15], v12 offset:928
    s_waitcnt lgkmcnt(9)
    v_mfma_f32_32x32x16_bf16 v[16:31], a[16:19], a[20:23], v[16:31]
    s_add_u32 m0, s56, 0x1d400
    s_add_u32 s20, s54, 0x14000
    s_cbranch_execz L_disp
    buffer_load_dwordx4 v3, s[48:51], s20 offen lds
    ds_read_b64_tr_b16 a[16:17], v8 offset:43008
    ds_read_b64_tr_b16 a[18:19], v8 offset:43264
    ds_read_b128 a[20:23], v12 offset:960
    s_waitcnt lgkmcnt(9)
    v_mfma_f32_32x32x16_bf16 v[16:31], a[24:27], a[28:31], v[16:31]
    ds_read_b64_tr_b16 a[24:25], v8 offset:46080
    ds_read_b64_tr_b16 a[26:27], v8 offset:46336
    ds_read_b128 a[28:31], v12 offset:992
    s_waitcnt lgkmcnt(9)
    v_mfma_f32_32x32x16_bf16 v[16:31], a[0:3], a[4:7], v[16:31]
    s_add_u32 m0, s56, 0x1ec00
    s_add_u32 s20, s54, 0x14040
    buffer_load_dwordx4 v3, s[48:51], s20 offen lds
    s_waitcnt lgkmcnt(6)
    v_mfma_f32_32x32x16_bf16 v[16:31], a[8:11], a[12:15], v[16:31]
    s_waitcnt lgkmcnt(3)
    v_mfma_f32_32x32x16_bf16 v[16:31], a[16:19], a[20:23], v[16:31]
    s_waitcnt lgkmcnt(0)
    v_mfma_f32_32x32x16_bf16 v[16:31], a[24:27], a[28:31], v[16:31]
    v_mov_b32 v32, 1.0
    v_mov_b32 v33, 0xbfb8aa3b
    v_cmp_eq_u32 vcc, 1, v11
    s_nop 1
    v_cndmask_b32 v32, v32, v33, vcc
    v_lshlrev_b32 v33, 7, v11
    v_lshl_add_u32 v33, v13, 6, v33
    v_add_u32 v33, s26, v33
    s_nop 2
    v_mul_f32 v16, v16, v32
    v_mul_f32 v17, v17, v32
    v_mul_f32 v18, v18, v32
    v_mul_f32 v19, v19, v32
    v_mul_f32 v20, v20, v32
    v_mul_f32 v21, v21, v32
    v_mul_f32 v22, v22, v32
    v_mul_f32 v23, v23, v32
    v_mul_f32 v24, v24, v32
    v_mul_f32 v25, v25, v32
    v_mul_f32 v26, v26, v32
    v_mul_f32 v27, v27, v32
    v_mul_f32 v28, v28, v32
    v_mul_f32 v29, v29, v32
    v_mul_f32 v30, v30, v32
    v_mul_f32 v31, v31, v32
    s_mov_b32 s22, 3
    s_cbranch_execz L_disp
    s_mov_b32 s23, 3
    s_mov_b64 exec, s[22:23]
    ds_write_b128 v33, v[16:19] offset:2048
    ds_write_b128 v33, v[20:23] offset:2064
    ds_write_b128 v33, v[24:27] offset:2080
    ds_write_b128 v33, v[28:31] offset:2096
    s_mov_b64 exec, -1
    s_nop 0
    s_branch L_ubj
L_noub:
    s_waitcnt vmcnt(0)
    s_mov_b64 exec, 1
    buffer_store_dword v254, off, s[28:31], s21
    s_add_u32 s21, s21, 0x8000
    buffer_store_dword v254, off, s[28:31], s21 sc1
    s_mov_b64 exec, -1
    s_add_u32 m0, s56, 0x1cc00
    s_add_u32 s20, s54, 0xc000
    buffer_load_dwordx4 v3, s[48:51], s20 offen lds
    s_add_u32 m0, s56, 0x1e400
    s_add_u32 s20, s54, 0xc040
    buffer_load_dwordx4 v3, s[48:51], s20 offen lds
    s_add_u32 m0, s56, 0x1d000
    s_add_u32 s20, s54, 0x10000
    buffer_load_dwordx4 v3, s[48:51], s20 offen lds
    s_add_u32 m0, s56, 0x1e800
    s_add_u32 s20, s54, 0x10040
    buffer_load_dwordx4 v3, s[48:51], s20 offen lds
    s_add_u32 m0, s56, 0x1d400
    s_add_u32 s20, s54, 0x14000
    buffer_load_dwordx4 v3, s[48:51], s20 offen lds
    s_add_u32 m0, s56, 0x1ec00
    s_add_u32 s20, s54, 0x14040
    buffer_load_dwordx4 v3, s[48:51], s20 offen lds
L_ubj:
    v_lshlrev_b32 v14, 2, v1
    s_lshl_b32 s21, s9, 7
    s_add_u32 s21, s21, 0x4000
    s_lshl_b32 s26, s9, 15
    s_cbranch_execz L_disp
    s_add_u32 s26, s26, 0x600000
    v_lshlrev_b32 v10, 3, v5
    v_lshl_add_u32 v10, v13, 11, v10
    s_lshl_b32 s27, s9, 12
    s_add_u32 s27, s27, 0x40000
    s_add_u32 s57, s56, 114688
    v_add_u32 v11, s57, v253
    ds_read_b64_tr_b16 a[128:129], v253 offset:0
    ds_read_b64_tr_b16 a[130:131], v253 offset:256
    ds_read_b64_tr_b16 a[132:133], v253 offset:1024
    ds_read_b64_tr_b16 a[134:135], v253 offset:1280
    ds_read_b64_tr_b16 a[136:137], v253 offset:3072
    ds_read_b64_tr_b16 a[138:139], v253 offset:3328
    ds_read_b64_tr_b16 a[140:141], v253 offset:4096
    ds_read_b64_tr_b16 a[142:143], v253 offset:4352
    v_lshlrev_b32 v12, 6, v13
    v_add_u32 v12, 98304, v12
    s_mov_b32 exec_lo, 0xffff
    s_mov_b32 exec_hi, 0
    s_mov_b32 s17, 0
    s_add_u32 s18, s21, 0x8000
    s_cmp_eq_u32 s16, 0
    s_nop 0
    s_cbranch_scc1 ps_13
pf_12:
    buffer_load_dword v16, v14, s[28:31], s21 offen sc1
    s_add_u32 s17, s17, 1
    s_waitcnt vmcnt(0)
    v_cmp_ne_u32 vcc, s6, v16
    s_nop 4
    s_cbranch_vccz pd_14
    s_cmp_lt_u32 s17, s16
    s_cbranch_scc1 pf_12
ps_13:
    buffer_load_dword v16, v14, s[28:31], s21 offen sc1
    buffer_load_dword v17, v14, s[28:31], s18 offen sc1
    s_add_u32 s17, s17, 1
    s_waitcnt vmcnt(0)
    v_cmp_ne_u32 s[22:23], s6, v16
    v_cmp_ne_u32 vcc, s6, v17
    s_nop 4
    s_and_b64 vcc, vcc, s[22:23]
    s_cmp_eq_u64 vcc, 0
    s_cbranch_scc1 pd_14
    s_cmp_lt_u32 s17, 30000
    s_cbranch_execz L_disp
    s_cbranch_scc1 ps_13
pd_14:
    s_mov_b64 exec, -1
    buffer_load_dwordx4 a[0:3], v2, s[28:31], s26 offen offset:0 sc1
    buffer_load_dwordx4 a[4:7], v2, s[28:31], s26 offen offset:1024 sc1
    buffer_load_dwordx4 a[8:11], v2, s[28:31], s26 offen offset:2048 sc1
    buffer_load_dwordx4 a[12:15], v2, s[28:31], s26 offen offset:3072 sc1
    s_add_u32 s26, s26, 4096
    buffer_load_dwordx4 a[16:19], v2, s[28:31], s26 offen offset:0 sc1
    buffer_load_dwordx4 a[20:23], v2, s[28:31], s26 offen offset:1024 sc1
    buffer_load_dwordx4 a[24:27], v2, s[28:31], s26 offen offset:2048 sc1
    buffer_load_dwordx4 a[28:31], v2, s[28:31], s26 offen offset:3072 sc1
    s_add_u32 s26, s26, 4096
    buffer_load_dwordx4 a[32:35], v2, s[28:31], s26 offen offset:0 sc1
    buffer_load_dwordx4 a[36:39], v2, s[28:31], s26 offen offset:1024 sc1
    s_waitcnt lgkmcnt(0)
    s_barrier
    s_waitcnt lgkmcnt(4)
    s_waitcnt vmcnt(9)
    v_mfma_f32_32x32x16_bf16 v[16:31], a[128:131], a[0:3], 0
    buffer_load_dwordx4 a[40:43], v2, s[28:31], s26 offen offset:2048 sc1
    buffer_load_dwordx4 a[44:47], v2, s[28:31], s26 offen offset:3072 sc1
    ds_read_b64_tr_b16 a[144:145], v253 offset:6144
    ds_read_b64_tr_b16 a[146:147], v253 offset:6400
    ds_read_b64_tr_b16 a[148:149], v253 offset:7168
    v_mfma_f32_32x32x16_bf16 v[32:47], a[132:135], a[0:3], 0
    ds_read_b64_tr_b16 a[150:151], v253 offset:7424
    ds_read_b128 v[64:67], v12 offset:10240
    ds_read_b128 v[80:83], v12 offset:10368
    ds_read_b128 v[68:71], v12 offset:10256
    s_waitcnt lgkmcnt(7)
    s_waitcnt vmcnt(10)
    v_mfma_f32_32x32x16_bf16 v[16:31], a[136:139], a[4:7], v[16:31]
    s_add_u32 s26, s26, 4096
    buffer_load_dwordx4 a[48:51], v2, s[28:31], s26 offen offset:0 sc1
    buffer_load_dwordx4 a[52:55], v2, s[28:31], s26 offen offset:1024 sc1
    s_nop 0
    s_cbranch_execz L_disp
    ds_read_b64_tr_b16 a[128:129], v253 offset:9216
    ds_read_b64_tr_b16 a[130:131], v253 offset:9472
    ds_read_b64_tr_b16 a[132:133], v253 offset:10240
    v_mfma_f32_32x32x16_bf16 v[32:47], a[140:143], a[4:7], v[32:47]
    ds_read_b64_tr_b16 a[134:135], v253 offset:10496
    ds_read_b128 v[84:87], v12 offset:10384
    ds_read_b128 v[72:75], v12 offset:10272
    ds_read_b128 v[88:91], v12 offset:10400
    s_waitcnt lgkmcnt(7)
    s_waitcnt vmcnt(11)
    v_mfma_f32_32x32x16_bf16 v[16:31], a[144:147], a[8:11], v[16:31]
    buffer_load_dwordx2 v[160:161], v10, s[28:31], s27 offen offset:0 sc1
    buffer_load_dwordx2 v[162:163], v10, s[28:31], s27 offen offset:256 sc1
    ds_read_b64_tr_b16 a[136:137], v253 offset:12288
    ds_read_b64_tr_b16 a[138:139], v253 offset:12544
    ds_read_b64_tr_b16 a[140:141], v253 offset:13312
    v_mfma_f32_32x32x16_bf16 v[32:47], a[148:151], a[8:11], v[32:47]
    ds_read_b64_tr_b16 a[142:143], v253 offset:13568
    ds_read_b128 v[76:79], v12 offset:10288
    ds_read_b128 v[92:95], v12 offset:10416
    ds_read_b128 v[96:99], v12 offset:14336
    s_waitcnt lgkmcnt(7)
    s_waitcnt vmcnt(12)
    v_mfma_f32_32x32x16_bf16 v[16:31], a[128:131], a[12:15], v[16:31]
    buffer_load_dwordx2 v[164:165], v10, s[28:31], s27 offen offset:512 sc1
    buffer_load_dwordx2 v[166:167], v10, s[28:31], s27 offen offset:768 sc1
    ds_read_b64_tr_b16 a[144:145], v253 offset:15360
    ds_read_b64_tr_b16 a[146:147], v253 offset:15616
    ds_read_b64_tr_b16 a[148:149], v253 offset:16384
    v_mfma_f32_32x32x16_bf16 v[32:47], a[132:135], a[12:15], v[32:47]
    ds_read_b64_tr_b16 a[150:151], v253 offset:16640
    ds_read_b128 v[112:115], v12 offset:14464
    ds_read_b128 v[100:103], v12 offset:14352
    s_nop 0
    s_cbranch_execz L_disp
    ds_read_b128 v[116:119], v12 offset:14480
    s_waitcnt lgkmcnt(7)
    s_waitcnt vmcnt(13)
    v_mfma_f32_32x32x16_bf16 v[16:31], a[136:139], a[16:19], v[16:31]
    buffer_load_dwordx2 v[168:169], v10, s[28:31], s27 offen offset:1024 sc1
    buffer_load_dwordx2 v[170:171], v10, s[28:31], s27 offen offset:1280 sc1
    ds_read_b64_tr_b16 a[128:129], v253 offset:18432
    ds_read_b64_tr_b16 a[130:131], v253 offset:18688
    ds_read_b64_tr_b16 a[132:133], v253 offset:19456
    v_mfma_f32_32x32x16_bf16 v[32:47], a[140:143], a[16:19], v[32:47]
    ds_read_b64_tr_b16 a[134:135], v253 offset:19712
    ds_read_b128 v[104:107], v12 offset:14368
    ds_read_b128 v[120:123], v12 offset:14496
    ds_read_b128 v[108:111], v12 offset:14384
    s_waitcnt lgkmcnt(7)
    s_waitcnt vmcnt(14)
    v_mfma_f32_32x32x16_bf16 v[16:31], a[144:147], a[20:23], v[16:31]
    buffer_load_dwordx2 v[172:173], v10, s[28:31], s27 offen offset:1536 sc1
    buffer_load_dwordx2 v[174:175], v10, s[28:31], s27 offen offset:1792 sc1
    ds_read_b64_tr_b16 a[136:137], v253 offset:21504
    ds_read_b64_tr_b16 a[138:139], v253 offset:21760
    ds_read_b64_tr_b16 a[140:141], v253 offset:22528
    v_mfma_f32_32x32x16_bf16 v[32:47], a[148:151], a[20:23], v[32:47]
    ds_read_b64_tr_b16 a[142:143], v253 offset:22784
    ds_read_b128 v[124:127], v12 offset:14512
    ds_read_b128 v[128:131], v12 offset:2048
    ds_read_b128 v[144:147], v12 offset:2176
    s_waitcnt lgkmcnt(7)
    s_waitcnt vmcnt(15)
    v_mfma_f32_32x32x16_bf16 v[16:31], a[128:131], a[24:27], v[16:31]
    buffer_load_dwordx4 a[56:59], v2, s[28:31], s26 offen offset:2048 sc1
    buffer_load_dwordx4 a[60:63], v2, s[28:31], s26 offen offset:3072 sc1
    ds_read_b64_tr_b16 a[144:145], v253 offset:24576
    ds_read_b64_tr_b16 a[146:147], v253 offset:24832
    s_nop 0
    s_cbranch_execz L_disp
    ds_read_b64_tr_b16 a[148:149], v253 offset:25600
    v_mfma_f32_32x32x16_bf16 v[32:47], a[132:135], a[24:27], v[32:47]
    ds_read_b64_tr_b16 a[150:151], v253 offset:25856
    ds_read_b128 v[132:135], v12 offset:2064
    ds_read_b128 v[148:151], v12 offset:2192
    ds_read_b128 v[136:139], v12 offset:2080
    s_waitcnt lgkmcnt(7)
    s_waitcnt vmcnt(16)
    v_mfma_f32_32x32x16_bf16 v[16:31], a[136:139], a[28:31], v[16:31]
    s_add_u32 s26, s26, 4096
    buffer_load_dwordx4 a[64:67], v2, s[28:31], s26 offen offset:0 sc1
    buffer_load_dwordx4 a[68:71], v2, s[28:31], s26 offen offset:1024 sc1
    ds_read_b64_tr_b16 a[128:129], v253 offset:27648
    ds_read_b64_tr_b16 a[130:131], v253 offset:27904
    ds_read_b64_tr_b16 a[132:133], v253 offset:28672
    v_mfma_f32_32x32x16_bf16 v[32:47], a[140:143], a[28:31], v[32:47]
    ds_read_b64_tr_b16 a[134:135], v253 offset:28928
    ds_read_b128 v[152:155], v12 offset:2208
    ds_read_b128 v[140:143], v12 offset:2096
    ds_read_b128 v[156:159], v12 offset:2224
    s_waitcnt lgkmcnt(7)
    s_waitcnt vmcnt(17)
    v_mfma_f32_32x32x16_bf16 v[16:31], a[144:147], a[32:35], v[16:31]
    buffer_load_dwordx4 a[72:75], v2, s[28:31], s26 offen offset:2048 sc1
    buffer_load_dwordx4 a[76:79], v2, s[28:31], s26 offen offset:3072 sc1
    ds_read_b64_tr_b16 a[136:137], v253 offset:30720
    ds_read_b64_tr_b16 a[138:139], v253 offset:30976
    ds_read_b64_tr_b16 a[140:141], v253 offset:31744
    v_mfma_f32_32x32x16_bf16 v[32:47], a[148:151], a[32:35], v[32:47]
    ds_read_b64_tr_b16 a[142:143], v253 offset:32000
    ds_read_b64_tr_b16 a[164:165], v11 offset:0
    ds_read_b64_tr_b16 a[166:167], v11 offset:256
    s_waitcnt lgkmcnt(6)
    s_waitcnt vmcnt(18)
    s_nop 0
    s_cbranch_execz L_disp
    v_mfma_f32_32x32x16_bf16 v[16:31], a[128:131], a[36:39], v[16:31]
    s_add_u32 s26, s26, 4096
    buffer_load_dwordx4 a[80:83], v2, s[28:31], s26 offen offset:0 sc1
    buffer_load_dwordx4 a[84:87], v2, s[28:31], s26 offen offset:1024 sc1
    ds_read_b64_tr_b16 a[144:145], v253 offset:33792
    ds_read_b64_tr_b16 a[146:147], v253 offset:34048
    ds_read_b64_tr_b16 a[148:149], v253 offset:34816
    v_mfma_f32_32x32x16_bf16 v[32:47], a[132:135], a[36:39], v[32:47]
    ds_read_b64_tr_b16 a[150:151], v253 offset:35072
    ds_read_b64_tr_b16 a[168:169], v11 offset:1024
    ds_read_b64_tr_b16 a[170:171], v11 offset:1280
    s_waitcnt lgkmcnt(6)
    s_waitcnt vmcnt(19)
    v_mfma_f32_32x32x16_bf16 v[16:31], a[136:139], a[40:43], v[16:31]
    buffer_load_dwordx4 a[88:91], v2, s[28:31], s26 offen offset:2048 sc1
    buffer_load_dwordx4 a[92:95], v2, s[28:31], s26 offen offset:3072 sc1
    ds_read_b64_tr_b16 a[128:129], v253 offset:36864
    ds_read_b64_tr_b16 a[130:131], v253 offset:37120
    ds_read_b64_tr_b16 a[132:133], v253 offset:37888
    v_mfma_f32_32x32x16_bf16 v[32:47], a[140:143], a[40:43], v[32:47]
    ds_read_b64_tr_b16 a[134:135], v253 offset:38144
    ds_read_b64_tr_b16 a[172:173], v11 offset:2048
    ds_read_b64_tr_b16 a[174:175], v11 offset:2304
    s_waitcnt lgkmcnt(6)
    s_waitcnt vmcnt(20)
    v_mfma_f32_32x32x16_bf16 v[16:31], a[144:147], a[44:47], v[16:31]
    s_add_u32 s26, s26, 4096
    buffer_load_dwordx4 a[96:99], v2, s[28:31], s26 offen offset:0 sc1
    buffer_load_dwordx4 a[100:103], v2, s[28:31], s26 offen offset:1024 sc1
    ds_read_b64_tr_b16 a[136:137], v253 offset:39936
    ds_read_b64_tr_b16 a[138:139], v253 offset:40192
    ds_read_b64_tr_b16 a[140:141], v253 offset:40960
    v_mfma_f32_32x32x16_bf16 v[32:47], a[148:151], a[44:47], v[32:47]
    s_nop 0
    s_cbranch_execz L_disp
    ds_read_b64_tr_b16 a[142:143], v253 offset:41216
    ds_read_b64_tr_b16 a[176:177], v11 offset:3072
    ds_read_b64_tr_b16 a[178:179], v11 offset:3328
    s_waitcnt lgkmcnt(6)
    s_waitcnt vmcnt(21)
    v_mfma_f32_32x32x16_bf16 v[16:31], a[128:131], a[48:51], v[16:31]
    buffer_load_dwordx4 a[104:107], v2, s[28:31], s26 offen offset:2048 sc1
    buffer_load_dwordx4 a[108:111], v2, s[28:31], s26 offen offset:3072 sc1
    ds_read_b64_tr_b16 a[144:145], v253 offset:43008
    ds_read_b64_tr_b16 a[146:147], v253 offset:43264
    ds_read_b64_tr_b16 a[148:149], v253 offset:44032
    v_mfma_f32_32x32x16_bf16 v[32:47], a[132:135], a[48:51], v[32:47]
    ds_read_b64_tr_b16 a[150:151], v253 offset:44288
    ds_read_b64_tr_b16 a[180:181], v11 offset:4096
    ds_read_b64_tr_b16 a[182:183], v11 offset:4352
    s_waitcnt lgkmcnt(6)
    s_waitcnt vmcnt(22)
    v_mfma_f32_32x32x16_bf16 v[16:31], a[136:139], a[52:55], v[16:31]
    s_add_u32 s26, s26, 4096
    buffer_load_dwordx4 a[112:115], v2, s[28:31], s26 offen offset:0 sc1
    buffer_load_dwordx4 a[116:119], v2, s[28:31], s26 offen offset:1024 sc1
    ds_read_b64_tr_b16 a[128:129], v253 offset:46080
    ds_read_b64_tr_b16 a[130:131], v253 offset:46336
    ds_read_b64_tr_b16 a[132:133], v253 offset:47104
    v_mfma_f32_32x32x16_bf16 v[32:47], a[140:143], a[52:55], v[32:47]
    ds_read_b64_tr_b16 a[134:135], v253 offset:47360
    ds_read_b64_tr_b16 a[184:185], v11 offset:5120
    ds_read_b64_tr_b16 a[186:187], v11 offset:5376
    s_waitcnt lgkmcnt(6)
    s_waitcnt vmcnt(15)
    v_mfma_f32_32x32x16_bf16 v[16:31], a[144:147], a[56:59], v[16:31]
    buffer_load_dwordx4 a[120:123], v2, s[28:31], s26 offen offset:2048 sc1
    buffer_load_dwordx4 a[124:127], v2, s[28:31], s26 offen offset:3072 sc1
    ds_read_b64_tr_b16 a[136:137], v9 offset:0
    s_nop 0
    s_cbranch_execz L_disp
    ds_read_b64_tr_b16 a[138:139], v9 offset:256
    ds_read_b64_tr_b16 a[140:141], v9 offset:1024
    v_mfma_f32_32x32x16_bf16 v[32:47], a[148:151], a[56:59], v[32:47]
    ds_read_b64_tr_b16 a[142:143], v9 offset:1280
    ds_read_b64_tr_b16 a[188:189], v11 offset:6144
    ds_read_b64_tr_b16 a[190:191], v11 offset:6400
    s_waitcnt lgkmcnt(6)
    s_waitcnt vmcnt(16)
    v_mfma_f32_32x32x16_bf16 v[16:31], a[128:131], a[60:63], v[16:31]
    v_lshlrev_b32 v15, 7, v1
    s_mul_i32 s23, s3, 21
    s_min_u32 s22, s3, 2
    s_add_u32 s23, s23, s22
    s_add_u32 s23, s23, 12
    s_lshl_b32 s23, s23, 14
    s_mul_i32 s22, s5, 5120
    s_add_u32 s23, s23, s22
    s_mov_b32 exec_lo, 0xffffffff
    s_mov_b32 exec_hi, 0xff
    buffer_load_dword v252, v15, s[48:51], s23 offen
    s_mov_b64 exec, -1
    ds_read_b64_tr_b16 a[144:145], v9 offset:3072
    ds_read_b64_tr_b16 a[146:147], v9 offset:3328
    ds_read_b64_tr_b16 a[148:149], v9 offset:4096
    v_mfma_f32_32x32x16_bf16 v[32:47], a[132:135], a[60:63], v[32:47]
    ds_read_b64_tr_b16 a[150:151], v9 offset:4352
    ds_read_b64_tr_b16 a[192:193], v11 offset:7168
    ds_read_b64_tr_b16 a[194:195], v11 offset:7424
    s_waitcnt lgkmcnt(6)
    s_waitcnt vmcnt(16)
    v_mfma_f32_32x32x16_bf16 v[16:31], a[136:139], a[64:67], v[16:31]
    ds_read_b64_tr_b16 a[128:129], v9 offset:6144
    ds_read_b64_tr_b16 a[130:131], v9 offset:6400
    ds_read_b64_tr_b16 a[132:133], v9 offset:7168
    v_mfma_f32_32x32x16_bf16 v[32:47], a[140:143], a[64:67], v[32:47]
    ds_read_b64_tr_b16 a[134:135], v9 offset:7424
    ds_read_b64_tr_b16 a[196:197], v11 offset:8192
    ds_read_b64_tr_b16 a[198:199], v11 offset:8448
    s_cbranch_execz L_disp
    s_waitcnt lgkmcnt(6)
    s_waitcnt vmcnt(15)
    v_mfma_f32_32x32x16_bf16 v[16:31], a[144:147], a[68:71], v[16:31]
    ds_read_b64_tr_b16 a[136:137], v9 offset:9216
    ds_read_b64_tr_b16 a[138:139], v9 offset:9472
    ds_read_b64_tr_b16 a[140:141], v9 offset:10240
    v_mfma_f32_32x32x16_bf16 v[32:47], a[148:151], a[68:71], v[32:47]
    ds_read_b64_tr_b16 a[142:143], v9 offset:10496
    ds_read_b64_tr_b16 a[200:201], v11 offset:9216
    ds_read_b64_tr_b16 a[202:203], v11 offset:9472
    s_waitcnt lgkmcnt(6)
    s_waitcnt vmcnt(14)
    v_mfma_f32_32x32x16_bf16 v[16:31], a[128:131], a[72:75], v[16:31]
    ds_read_b64_tr_b16 a[144:145], v9 offset:12288
    ds_read_b64_tr_b16 a[146:147], v9 offset:12544
    ds_read_b64_tr_b16 a[148:149], v9 offset:13312
    v_mfma_f32_32x32x16_bf16 v[32:47], a[132:135], a[72:75], v[32:47]
    ds_read_b64_tr_b16 a[150:151], v9 offset:13568
    ds_read_b64_tr_b16 a[204:205], v11 offset:10240
    ds_read_b64_tr_b16 a[206:207], v11 offset:10496
    s_waitcnt lgkmcnt(6)
    s_waitcnt vmcnt(13)
    v_mfma_f32_32x32x16_bf16 v[16:31], a[136:139], a[76:79], v[16:31]
    ds_read_b64_tr_b16 a[128:129], v9 offset:15360
    ds_read_b64_tr_b16 a[130:131], v9 offset:15616
    ds_read_b64_tr_b16 a[132:133], v9 offset:16384
    v_mfma_f32_32x32x16_bf16 v[32:47], a[140:143], a[76:79], v[32:47]
    ds_read_b64_tr_b16 a[134:135], v9 offset:16640
    ds_read_b64_tr_b16 a[208:209], v11 offset:11264
    ds_read_b64_tr_b16 a[210:211], v11 offset:11520
    s_waitcnt lgkmcnt(6)
    s_waitcnt vmcnt(12)
    v_mfma_f32_32x32x16_bf16 v[16:31], a[144:147], a[80:83], v[16:31]
    ds_read_b64_tr_b16 a[136:137], v9 offset:18432
    ds_read_b64_tr_b16 a[138:139], v9 offset:18688
    s_nop 0
    s_cbranch_execz L_disp
    v_mfma_f32_32x32x16_bf16 v[32:47], a[148:151], a[80:83], v[32:47]
    ds_read_b64_tr_b16 a[140:141], v9 offset:19456
    ds_read_b64_tr_b16 a[142:143], v9 offset:19712
    s_waitcnt lgkmcnt(4)
    s_waitcnt vmcnt(11)
    v_mfma_f32_32x32x16_bf16 v[16:31], a[128:131], a[84:87], v[16:31]
    ds_read_b64_tr_b16 a[144:145], v9 offset:21504
    ds_read_b64_tr_b16 a[146:147], v9 offset:21760
    v_pk_add_f32 v[160:161], v[160:161], v[168:169]
    v_pk_add_f32 v[162:163], v[162:163], v[170:171]
    v_mfma_f32_32x32x16_bf16 v[32:47], a[132:135], a[84:87], v[32:47]
    ds_read_b64_tr_b16 a[148:149], v9 offset:22528
    ds_read_b64_tr_b16 a[150:151], v9 offset:22784
    v_pk_add_f32 v[164:165], v[164:165], v[172:173]
    v_pk_add_f32 v[166:167], v[166:167], v[174:175]
    v_pk_add_f32 v[160:161], v[160:161], v[164:165]
    s_waitcnt lgkmcnt(4)
    s_waitcnt vmcnt(10)
    v_mfma_f32_32x32x16_bf16 v[16:31], a[136:139], a[88:91], v[16:31]
    ds_read_b64_tr_b16 a[128:129], v9 offset:24576
    ds_read_b64_tr_b16 a[130:131], v9 offset:24832
    v_pk_add_f32 v[162:163], v[162:163], v[166:167]
    v_pk_add_f32 v[160:161], v[160:161], v[162:163]
    v_mfma_f32_32x32x16_bf16 v[32:47], a[140:143], a[88:91], v[32:47]
    ds_read_b64_tr_b16 a[132:133], v9 offset:25600
    ds_read_b64_tr_b16 a[134:135], v9 offset:25856
    v_mov_b32 v162, v160
    v_mov_b32 v163, v161
    s_waitcnt lgkmcnt(4)
    s_waitcnt vmcnt(9)
    v_mfma_f32_32x32x16_bf16 v[16:31], a[144:147], a[92:95], v[16:31]
    ds_read_b64_tr_b16 a[136:137], v9 offset:27648
    ds_read_b64_tr_b16 a[138:139], v9 offset:27904
    v_permlane32_swap_b32 v160, v162
    v_permlane32_swap_b32 v161, v163
    v_mfma_f32_32x32x16_bf16 v[32:47], a[148:151], a[92:95], v[32:47]
    s_nop 0
    s_cbranch_execz L_disp
    ds_read_b64_tr_b16 a[140:141], v9 offset:28672
    ds_read_b64_tr_b16 a[142:143], v9 offset:28928
    v_add_f32 v160, v160, v162
    v_add_f32 v161, v161, v163
    s_waitcnt lgkmcnt(4)
    s_waitcnt vmcnt(8)
    v_mfma_f32_32x32x16_bf16 v[16:31], a[128:131], a[96:99], v[16:31]
    ds_read_b64_tr_b16 a[144:145], v9 offset:30720
    ds_read_b64_tr_b16 a[146:147], v9 offset:30976
    v_mul_f32 v160, 0x3b000000, v160
    v_mul_f32 v162, 0x3b000000, v161
    v_mfma_f32_32x32x16_bf16 v[32:47], a[132:135], a[96:99], v[32:47]
    ds_read_b64_tr_b16 a[148:149], v9 offset:31744
    ds_read_b64_tr_b16 a[150:151], v9 offset:32000
    v_fma_f32 v162, -v160, v160, v162
    v_max_f32 v162, 0, v162
    s_waitcnt lgkmcnt(4)
    s_waitcnt vmcnt(7)
    v_mfma_f32_32x32x16_bf16 v[16:31], a[136:139], a[100:103], v[16:31]
    ds_read_b64_tr_b16 a[128:129], v9 offset:33792
    ds_read_b64_tr_b16 a[130:131], v9 offset:34048
    v_add_f32 v162, 0x3727c5ac, v162
    v_rsq_f32 v162, v162
    v_mfma_f32_32x32x16_bf16 v[32:47], a[140:143], a[100:103], v[32:47]
    ds_read_b64_tr_b16 a[132:133], v9 offset:34816
    ds_read_b64_tr_b16 a[134:135], v9 offset:35072
    v_mul_f32 v162, 0xbfb8aa3b, v162
    v_mul_f32 v160, -v160, v162
    s_waitcnt lgkmcnt(4)
    s_waitcnt vmcnt(6)
    v_mfma_f32_32x32x16_bf16 v[16:31], a[144:147], a[104:107], v[16:31]
    ds_read_b64_tr_b16 a[136:137], v9 offset:36864
    ds_read_b64_tr_b16 a[138:139], v9 offset:37120
    v_pk_fma_f32 v[80:81], v[64:65], v[160:161], v[80:81] op_sel_hi:[1,0,1]
    v_pk_fma_f32 v[82:83], v[66:67], v[160:161], v[82:83] op_sel_hi:[1,0,1]
    v_mfma_f32_32x32x16_bf16 v[32:47], a[148:151], a[104:107], v[32:47]
    s_nop 0
    s_cbranch_execz L_disp
    ds_read_b64_tr_b16 a[140:141], v9 offset:37888
    ds_read_b64_tr_b16 a[142:143], v9 offset:38144
    v_pk_fma_f32 v[84:85], v[68:69], v[160:161], v[84:85] op_sel_hi:[1,0,1]
    v_pk_fma_f32 v[86:87], v[70:71], v[160:161], v[86:87] op_sel_hi:[1,0,1]
    s_waitcnt lgkmcnt(4)
    s_waitcnt vmcnt(5)
    v_mfma_f32_32x32x16_bf16 v[16:31], a[128:131], a[108:111], v[16:31]
    ds_read_b64_tr_b16 a[144:145], v9 offset:39936
    ds_read_b64_tr_b16 a[146:147], v9 offset:40192
    v_pk_fma_f32 v[88:89], v[72:73], v[160:161], v[88:89] op_sel_hi:[1,0,1]
    v_pk_fma_f32 v[90:91], v[74:75], v[160:161], v[90:91] op_sel_hi:[1,0,1]
    v_mfma_f32_32x32x16_bf16 v[32:47], a[132:135], a[108:111], v[32:47]
    ds_read_b64_tr_b16 a[148:149], v9 offset:40960
    ds_read_b64_tr_b16 a[150:151], v9 offset:41216
    v_pk_fma_f32 v[92:93], v[76:77], v[160:161], v[92:93] op_sel_hi:[1,0,1]
    v_pk_fma_f32 v[94:95], v[78:79], v[160:161], v[94:95] op_sel_hi:[1,0,1]
    s_waitcnt lgkmcnt(4)
    s_waitcnt vmcnt(4)
    v_mfma_f32_32x32x16_bf16 v[16:31], a[136:139], a[112:115], v[16:31]
    ds_read_b64_tr_b16 a[128:129], v9 offset:43008
    ds_read_b64_tr_b16 a[130:131], v9 offset:43264
    v_pk_fma_f32 v[112:113], v[96:97], v[160:161], v[112:113] op_sel_hi:[1,0,1]
    v_pk_fma_f32 v[114:115], v[98:99], v[160:161], v[114:115] op_sel_hi:[1,0,1]
    v_mfma_f32_32x32x16_bf16 v[32:47], a[140:143], a[112:115], v[32:47]
    ds_read_b64_tr_b16 a[132:133], v9 offset:44032
    ds_read_b64_tr_b16 a[134:135], v9 offset:44288
    v_pk_fma_f32 v[116:117], v[100:101], v[160:161], v[116:117] op_sel_hi:[1,0,1]
    v_pk_fma_f32 v[118:119], v[102:103], v[160:161], v[118:119] op_sel_hi:[1,0,1]
    s_waitcnt lgkmcnt(4)
    s_waitcnt vmcnt(3)
    v_mfma_f32_32x32x16_bf16 v[16:31], a[144:147], a[116:119], v[16:31]
    ds_read_b64_tr_b16 a[136:137], v9 offset:46080
    ds_read_b64_tr_b16 a[138:139], v9 offset:46336
    ds_read_b64_tr_b16 a[140:141], v9 offset:47104
    s_nop 0
    s_cbranch_execz L_disp
    v_pk_fma_f32 v[120:121], v[104:105], v[160:161], v[120:121] op_sel_hi:[1,0,1]
    v_pk_fma_f32 v[122:123], v[106:107], v[160:161], v[122:123] op_sel_hi:[1,0,1]
    v_mfma_f32_32x32x16_bf16 v[32:47], a[148:151], a[116:119], v[32:47]
    ds_read_b64_tr_b16 a[142:143], v9 offset:47360
    ds_read_b64_tr_b16 a[152:153], v253 offset:2048
    ds_read_b64_tr_b16 a[154:155], v253 offset:2304
    v_pk_fma_f32 v[124:125], v[108:109], v[160:161], v[124:125] op_sel_hi:[1,0,1]
    v_pk_fma_f32 v[126:127], v[110:111], v[160:161], v[126:127] op_sel_hi:[1,0,1]
    s_waitcnt lgkmcnt(6)
    s_waitcnt vmcnt(2)
    v_mfma_f32_32x32x16_bf16 v[16:31], a[128:131], a[120:123], v[16:31]
    ds_read_b64_tr_b16 a[156:157], v253 offset:5120
    v_pk_fma_f32 v[144:145], v[128:129], v[160:161], v[144:145] op_sel_hi:[1,0,1]
    v_pk_fma_f32 v[146:147], v[130:131], v[160:161], v[146:147] op_sel_hi:[1,0,1]
    v_mfma_f32_32x32x16_bf16 v[32:47], a[132:135], a[120:123], v[32:47]
    ds_read_b64_tr_b16 a[158:159], v253 offset:5376
    v_pk_fma_f32 v[148:149], v[132:133], v[160:161], v[148:149] op_sel_hi:[1,0,1]
    v_pk_fma_f32 v[150:151], v[134:135], v[160:161], v[150:151] op_sel_hi:[1,0,1]
    s_waitcnt lgkmcnt(2)
    s_waitcnt vmcnt(1)
    v_mfma_f32_32x32x16_bf16 v[16:31], a[136:139], a[124:127], v[16:31]
    ds_read_b64_tr_b16 a[160:161], v253 offset:8192
    v_pk_fma_f32 v[152:153], v[136:137], v[160:161], v[152:153] op_sel_hi:[1,0,1]
    v_pk_fma_f32 v[154:155], v[138:139], v[160:161], v[154:155] op_sel_hi:[1,0,1]
    v_mfma_f32_32x32x16_bf16 v[32:47], a[140:143], a[124:127], v[32:47]
    ds_read_b64_tr_b16 a[162:163], v253 offset:8448
    v_pk_fma_f32 v[156:157], v[140:141], v[160:161], v[156:157] op_sel_hi:[1,0,1]
    v_pk_fma_f32 v[158:159], v[142:143], v[160:161], v[158:159] op_sel_hi:[1,0,1]
    s_mul_i32 s26, s9, 88064
    s_lshl_b32 s27, s96, 11
    s_add_u32 s26, s26, s27
    s_add_u32 s26, s26, 0x800000
    s_waitcnt lgkmcnt(4)
    v_mfma_f32_32x32x16_bf16 v[48:63], a[152:155], a[0:3], 0
    ds_read_b64_tr_b16 a[128:129], v253 offset:11264
    s_cbranch_execz L_disp
    ds_read_b64_tr_b16 a[130:131], v253 offset:11520
    s_add_u32 m0, s56, 0x1c000
    s_add_u32 s20, s54, 0x18000
    buffer_load_dwordx4 v3, s[48:51], s20 offen lds
    v_pk_fma_f32 v[16:17], v[16:17], v[162:163], v[80:81] op_sel_hi:[1,0,1]
    v_pk_fma_f32 v[18:19], v[18:19], v[162:163], v[82:83] op_sel_hi:[1,0,1]
    v_pk_fma_f32 v[20:21], v[20:21], v[162:163], v[84:85] op_sel_hi:[1,0,1]
    v_pk_fma_f32 v[22:23], v[22:23], v[162:163], v[86:87] op_sel_hi:[1,0,1]
    s_waitcnt lgkmcnt(4)
    v_mfma_f32_32x32x16_bf16 v[48:63], a[156:159], a[4:7], v[48:63]
    ds_read_b64_tr_b16 a[132:133], v253 offset:14336
    ds_read_b64_tr_b16 a[134:135], v253 offset:14592
    v_pk_fma_f32 v[24:25], v[24:25], v[162:163], v[88:89] op_sel_hi:[1,0,1]
    v_pk_fma_f32 v[26:27], v[26:27], v[162:163], v[90:91] op_sel_hi:[1,0,1]
    v_pk_fma_f32 v[28:29], v[28:29], v[162:163], v[92:93] op_sel_hi:[1,0,1]
    v_pk_fma_f32 v[30:31], v[30:31], v[162:163], v[94:95] op_sel_hi:[1,0,1]
    s_waitcnt lgkmcnt(4)
    v_mfma_f32_32x32x16_bf16 v[48:63], a[160:163], a[8:11], v[48:63]
    ds_read_b64_tr_b16 a[136:137], v253 offset:17408
    ds_read_b64_tr_b16 a[138:139], v253 offset:17664
    s_add_u32 m0, s56, 0x1d800
    s_add_u32 s20, s54, 0x18040
    buffer_load_dwordx4 v3, s[48:51], s20 offen lds
    v_exp_f32 v64, v16
    v_exp_f32 v65, v17
    v_exp_f32 v66, v18
    v_exp_f32 v67, v19
    s_waitcnt lgkmcnt(4)
    v_mfma_f32_32x32x16_bf16 v[48:63], a[128:131], a[12:15], v[48:63]
    ds_read_b64_tr_b16 a[140:141], v253 offset:20480
    ds_read_b64_tr_b16 a[142:143], v253 offset:20736
    v_exp_f32 v68, v20
    v_exp_f32 v69, v21
    v_exp_f32 v70, v22
    v_exp_f32 v71, v23
    s_waitcnt lgkmcnt(4)
    v_mfma_f32_32x32x16_bf16 v[48:63], a[132:135], a[16:19], v[48:63]
    s_nop 0
    s_cbranch_execz L_disp
    ds_read_b64_tr_b16 a[144:145], v253 offset:23552
    ds_read_b64_tr_b16 a[146:147], v253 offset:23808
    s_add_u32 m0, s56, 0x1c400
    s_add_u32 s20, s54, 0x1c000
    buffer_load_dwordx4 v3, s[48:51], s20 offen lds
    v_exp_f32 v72, v24
    v_exp_f32 v73, v25
    v_exp_f32 v74, v26
    v_exp_f32 v75, v27
    s_waitcnt lgkmcnt(4)
    v_mfma_f32_32x32x16_bf16 v[48:63], a[136:139], a[20:23], v[48:63]
    ds_read_b64_tr_b16 a[148:149], v253 offset:26624
    ds_read_b64_tr_b16 a[150:151], v253 offset:26880
    v_exp_f32 v76, v28
    v_exp_f32 v77, v29
    v_exp_f32 v78, v30
    v_exp_f32 v79, v31
    s_waitcnt lgkmcnt(4)
    v_mfma_f32_32x32x16_bf16 v[48:63], a[140:143], a[24:27], v[48:63]
    ds_read_b64_tr_b16 a[152:153], v253 offset:29696
    ds_read_b64_tr_b16 a[154:155], v253 offset:29952
    s_add_u32 m0, s56, 0x1dc00
    s_add_u32 s20, s54, 0x1c040
    buffer_load_dwordx4 v3, s[48:51], s20 offen lds
    v_pk_add_f32 v[64:65], v[64:65], 1.0 op_sel_hi:[1,0]
    v_pk_add_f32 v[66:67], v[66:67], 1.0 op_sel_hi:[1,0]
    v_pk_add_f32 v[68:69], v[68:69], 1.0 op_sel_hi:[1,0]
    v_pk_add_f32 v[70:71], v[70:71], 1.0 op_sel_hi:[1,0]
    s_waitcnt lgkmcnt(4)
    v_mfma_f32_32x32x16_bf16 v[48:63], a[144:147], a[28:31], v[48:63]
    ds_read_b64_tr_b16 a[156:157], v253 offset:32768
    ds_read_b64_tr_b16 a[158:159], v253 offset:33024
    v_pk_add_f32 v[72:73], v[72:73], 1.0 op_sel_hi:[1,0]
    v_pk_add_f32 v[74:75], v[74:75], 1.0 op_sel_hi:[1,0]
    v_pk_add_f32 v[76:77], v[76:77], 1.0 op_sel_hi:[1,0]
    v_pk_add_f32 v[78:79], v[78:79], 1.0 op_sel_hi:[1,0]
    s_waitcnt lgkmcnt(4)
    s_nop 0
    s_cbranch_execz L_disp
    v_mfma_f32_32x32x16_bf16 v[48:63], a[148:151], a[32:35], v[48:63]
    ds_read_b64_tr_b16 a[160:161], v253 offset:35840
    ds_read_b64_tr_b16 a[162:163], v253 offset:36096
    s_add_u32 m0, s56, 0x1c800
    s_add_u32 s20, s54, 0x20000
    buffer_load_dwordx4 v3, s[48:51], s20 offen lds
    v_rcp_f32 v64, v64
    v_rcp_f32 v65, v65
    v_rcp_f32 v66, v66
    v_rcp_f32 v67, v67
    s_waitcnt lgkmcnt(4)
    v_mfma_f32_32x32x16_bf16 v[48:63], a[152:155], a[36:39], v[48:63]
    ds_read_b64_tr_b16 a[128:129], v253 offset:38912
    ds_read_b64_tr_b16 a[130:131], v253 offset:39168
    v_rcp_f32 v68, v68
    v_rcp_f32 v69, v69
    v_rcp_f32 v70, v70
    v_rcp_f32 v71, v71
    s_waitcnt lgkmcnt(4)
    v_mfma_f32_32x32x16_bf16 v[48:63], a[156:159], a[40:43], v[48:63]
    ds_read_b64_tr_b16 a[132:133], v253 offset:41984
    ds_read_b64_tr_b16 a[134:135], v253 offset:42240
    s_add_u32 m0, s56, 0x1e000
    s_add_u32 s20, s54, 0x20040
    buffer_load_dwordx4 v3, s[48:51], s20 offen lds
    v_rcp_f32 v72, v72
    v_rcp_f32 v73, v73
    v_rcp_f32 v74, v74
    v_rcp_f32 v75, v75
    s_waitcnt lgkmcnt(4)
    v_mfma_f32_32x32x16_bf16 v[48:63], a[160:163], a[44:47], v[48:63]
    ds_read_b64_tr_b16 a[136:137], v253 offset:45056
    ds_read_b64_tr_b16 a[138:139], v253 offset:45312
    v_rcp_f32 v76, v76
    v_rcp_f32 v77, v77
    v_rcp_f32 v78, v78
    v_rcp_f32 v79, v79
    s_waitcnt lgkmcnt(4)
    v_mfma_f32_32x32x16_bf16 v[48:63], a[128:131], a[48:51], v[48:63]
    ds_read_b64_tr_b16 a[140:141], v253 offset:48128
    ds_read_b64_tr_b16 a[142:143], v253 offset:48384
    s_nop 0
    s_cbranch_execz L_disp
    s_add_u32 m0, s56, 0x1cc00
    s_add_u32 s20, s54, 0x24000
    buffer_load_dwordx4 v3, s[48:51], s20 offen lds
    v_pk_mul_f32 v[16:17], v[16:17], v[64:65]
    v_pk_mul_f32 v[18:19], v[18:19], v[66:67]
    v_pk_mul_f32 v[20:21], v[20:21], v[68:69]
    v_pk_mul_f32 v[22:23], v[22:23], v[70:71]
    s_waitcnt lgkmcnt(4)
    v_mfma_f32_32x32x16_bf16 v[48:63], a[132:135], a[52:55], v[48:63]
    ds_read_b64_tr_b16 a[144:145], v9 offset:2048
    ds_read_b64_tr_b16 a[146:147], v9 offset:2304
    v_pk_mul_f32 v[24:25], v[24:25], v[72:73]
    v_pk_mul_f32 v[26:27], v[26:27], v[74:75]
    v_pk_mul_f32 v[28:29], v[28:29], v[76:77]
    v_pk_mul_f32 v[30:31], v[30:31], v[78:79]
    s_waitcnt lgkmcnt(4)
    v_mfma_f32_32x32x16_bf16 v[48:63], a[136:139], a[56:59], v[48:63]
    ds_read_b64_tr_b16 a[148:149], v9 offset:5120
    ds_read_b64_tr_b16 a[150:151], v9 offset:5376
    s_add_u32 m0, s56, 0x1e400
    s_add_u32 s20, s54, 0x24040
    buffer_load_dwordx4 v3, s[48:51], s20 offen lds
    v_cvt_pk_bf16_f32 v80, v16, v17
    v_cvt_pk_bf16_f32 v81, v18, v19
    v_cvt_pk_bf16_f32 v82, v20, v21
    v_cvt_pk_bf16_f32 v83, v22, v23
    s_waitcnt lgkmcnt(4)
    v_mfma_f32_32x32x16_bf16 v[48:63], a[140:143], a[60:63], v[48:63]
    ds_read_b64_tr_b16 a[152:153], v9 offset:8192
    ds_read_b64_tr_b16 a[154:155], v9 offset:8448
    v_cvt_pk_bf16_f32 v84, v24, v25
    v_cvt_pk_bf16_f32 v85, v26, v27
    v_cvt_pk_bf16_f32 v86, v28, v29
    s_cbranch_execz L_disp
    v_cvt_pk_bf16_f32 v87, v30, v31
    buffer_store_dwordx4 v[80:83], v2, s[28:31], s26 offen offset:0 sc1
    buffer_store_dwordx4 v[84:87], v2, s[28:31], s26 offen offset:1024 sc1
    s_waitcnt lgkmcnt(4)
    v_mfma_f32_32x32x16_bf16 v[48:63], a[144:147], a[64:67], v[48:63]
    ds_read_b64_tr_b16 a[156:157], v9 offset:11264
    ds_read_b64_tr_b16 a[158:159], v9 offset:11520
    s_add_u32 m0, s56, 0x1d000
    s_add_u32 s20, s54, 0x28000
    buffer_load_dwordx4 v3, s[48:51], s20 offen lds
    v_pk_fma_f32 v[32:33], v[32:33], v[162:163], v[112:113] op_sel_hi:[1,0,1]
    v_pk_fma_f32 v[34:35], v[34:35], v[162:163], v[114:115] op_sel_hi:[1,0,1]
    v_pk_fma_f32 v[36:37], v[36:37], v[162:163], v[116:117] op_sel_hi:[1,0,1]
    v_pk_fma_f32 v[38:39], v[38:39], v[162:163], v[118:119] op_sel_hi:[1,0,1]
    s_waitcnt lgkmcnt(4)
    v_mfma_f32_32x32x16_bf16 v[48:63], a[148:151], a[68:71], v[48:63]
    ds_read_b64_tr_b16 a[160:161], v9 offset:14336
    ds_read_b64_tr_b16 a[162:163], v9 offset:14592
    v_pk_fma_f32 v[40:41], v[40:41], v[162:163], v[120:121] op_sel_hi:[1,0,1]
    v_pk_fma_f32 v[42:43], v[42:43], v[162:163], v[122:123] op_sel_hi:[1,0,1]
    v_pk_fma_f32 v[44:45], v[44:45], v[162:163], v[124:125] op_sel_hi:[1,0,1]
    v_pk_fma_f32 v[46:47], v[46:47], v[162:163], v[126:127] op_sel_hi:[1,0,1]
    s_waitcnt lgkmcnt(4)
    v_mfma_f32_32x32x16_bf16 v[48:63], a[152:155], a[72:75], v[48:63]
    ds_read_b64_tr_b16 a[128:129], v9 offset:17408
    ds_read_b64_tr_b16 a[130:131], v9 offset:17664
    s_add_u32 m0, s56, 0x1e800
    s_add_u32 s20, s54, 0x28040
    buffer_load_dwordx4 v3, s[48:51], s20 offen lds
    v_exp_f32 v96, v32
    v_exp_f32 v97, v33
    v_exp_f32 v98, v34
    v_exp_f32 v99, v35
    s_waitcnt lgkmcnt(4)
    v_mfma_f32_32x32x16_bf16 v[48:63], a[156:159], a[76:79], v[48:63]
    s_nop 0
    s_cbranch_execz L_disp
    ds_read_b64_tr_b16 a[132:133], v9 offset:20480
    ds_read_b64_tr_b16 a[134:135], v9 offset:20736
    v_exp_f32 v100, v36
    v_exp_f32 v101, v37
    v_exp_f32 v102, v38
    v_exp_f32 v103, v39
    s_waitcnt lgkmcnt(4)
    v_mfma_f32_32x32x16_bf16 v[48:63], a[160:163], a[80:83], v[48:63]
    ds_read_b64_tr_b16 a[136:137], v9 offset:23552
    ds_read_b64_tr_b16 a[138:139], v9 offset:23808
    s_add_u32 m0, s56, 0x1d400
    s_add_u32 s20, s54, 0x2c000
    buffer_load_dwordx4 v3, s[48:51], s20 offen lds
    v_exp_f32 v104, v40
    v_exp_f32 v105, v41
    v_exp_f32 v106, v42
    v_exp_f32 v107, v43
    s_waitcnt lgkmcnt(4)
    v_mfma_f32_32x32x16_bf16 v[48:63], a[128:131], a[84:87], v[48:63]
    ds_read_b64_tr_b16 a[140:141], v9 offset:26624
    ds_read_b64_tr_b16 a[142:143], v9 offset:26880
    v_exp_f32 v108, v44
    v_exp_f32 v109, v45
    v_exp_f32 v110, v46
    v_exp_f32 v111, v47
    s_waitcnt lgkmcnt(4)
    v_mfma_f32_32x32x16_bf16 v[48:63], a[132:135], a[88:91], v[48:63]
    ds_read_b64_tr_b16 a[144:145], v9 offset:29696
    ds_read_b64_tr_b16 a[146:147], v9 offset:29952
    s_add_u32 m0, s56, 0x1ec00
    s_add_u32 s20, s54, 0x2c040
    buffer_load_dwordx4 v3, s[48:51], s20 offen lds
    v_pk_add_f32 v[96:97], v[96:97], 1.0 op_sel_hi:[1,0]
    v_pk_add_f32 v[98:99], v[98:99], 1.0 op_sel_hi:[1,0]
    v_pk_add_f32 v[100:101], v[100:101], 1.0 op_sel_hi:[1,0]
    v_pk_add_f32 v[102:103], v[102:103], 1.0 op_sel_hi:[1,0]
    s_waitcnt lgkmcnt(4)
    v_mfma_f32_32x32x16_bf16 v[48:63], a[136:139], a[92:95], v[48:63]
    ds_read_b64_tr_b16 a[148:149], v9 offset:32768
    s_nop 0
    s_cbranch_execz L_disp
    ds_read_b64_tr_b16 a[150:151], v9 offset:33024
    v_pk_add_f32 v[104:105], v[104:105], 1.0 op_sel_hi:[1,0]
    v_pk_add_f32 v[106:107], v[106:107], 1.0 op_sel_hi:[1,0]
    v_pk_add_f32 v[108:109], v[108:109], 1.0 op_sel_hi:[1,0]
    v_pk_add_f32 v[110:111], v[110:111], 1.0 op_sel_hi:[1,0]
    s_waitcnt lgkmcnt(4)
    v_mfma_f32_32x32x16_bf16 v[48:63], a[140:143], a[96:99], v[48:63]
    ds_read_b64_tr_b16 a[152:153], v9 offset:35840
    ds_read_b64_tr_b16 a[154:155], v9 offset:36096
    v_rcp_f32 v96, v96
    v_rcp_f32 v97, v97
    v_rcp_f32 v98, v98
    v_rcp_f32 v99, v99
    s_waitcnt lgkmcnt(4)
    v_mfma_f32_32x32x16_bf16 v[48:63], a[144:147], a[100:103], v[48:63]
    ds_read_b64_tr_b16 a[156:157], v9 offset:38912
    ds_read_b64_tr_b16 a[158:159], v9 offset:39168
    v_rcp_f32 v100, v100
    v_rcp_f32 v101, v101
    v_rcp_f32 v102, v102
    v_rcp_f32 v103, v103
    s_waitcnt lgkmcnt(4)
    v_mfma_f32_32x32x16_bf16 v[48:63], a[148:151], a[104:107], v[48:63]
    ds_read_b64_tr_b16 a[160:161], v9 offset:41984
    ds_read_b64_tr_b16 a[162:163], v9 offset:42240
    v_rcp_f32 v104, v104
    v_rcp_f32 v105, v105
    v_rcp_f32 v106, v106
    v_rcp_f32 v107, v107
    s_waitcnt lgkmcnt(4)
    v_mfma_f32_32x32x16_bf16 v[48:63], a[152:155], a[108:111], v[48:63]
    ds_read_b64_tr_b16 a[128:129], v9 offset:45056
    ds_read_b64_tr_b16 a[130:131], v9 offset:45312
    v_rcp_f32 v108, v108
    v_rcp_f32 v109, v109
    v_rcp_f32 v110, v110
    v_rcp_f32 v111, v111
    s_waitcnt lgkmcnt(4)
    v_mfma_f32_32x32x16_bf16 v[48:63], a[156:159], a[112:115], v[48:63]
    ds_read_b64_tr_b16 a[132:133], v9 offset:48128
    ds_read_b64_tr_b16 a[134:135], v9 offset:48384
    v_pk_mul_f32 v[32:33], v[32:33], v[96:97]
    s_cbranch_execz L_disp
    v_pk_mul_f32 v[34:35], v[34:35], v[98:99]
    v_pk_mul_f32 v[36:37], v[36:37], v[100:101]
    v_pk_mul_f32 v[38:39], v[38:39], v[102:103]
    s_waitcnt lgkmcnt(4)
    v_mfma_f32_32x32x16_bf16 v[48:63], a[160:163], a[116:119], v[48:63]
    v_pk_mul_f32 v[40:41], v[40:41], v[104:105]
    v_pk_mul_f32 v[42:43], v[42:43], v[106:107]
    v_pk_mul_f32 v[44:45], v[44:45], v[108:109]
    v_pk_mul_f32 v[46:47], v[46:47], v[110:111]
    s_waitcnt lgkmcnt(2)
    v_mfma_f32_32x32x16_bf16 v[48:63], a[128:131], a[120:123], v[48:63]
    v_cvt_pk_bf16_f32 v112, v32, v33
    v_cvt_pk_bf16_f32 v113, v34, v35
    v_cvt_pk_bf16_f32 v114, v36, v37
    v_cvt_pk_bf16_f32 v115, v38, v39
    s_waitcnt lgkmcnt(0)
    v_mfma_f32_32x32x16_bf16 v[48:63], a[132:135], a[124:127], v[48:63]
    v_cvt_pk_bf16_f32 v116, v40, v41
    v_cvt_pk_bf16_f32 v117, v42, v43
    v_cvt_pk_bf16_f32 v118, v44, v45
    v_cvt_pk_bf16_f32 v119, v46, v47
    buffer_store_dwordx4 v[112:115], v2, s[28:31], s26 offen offset:2048 sc1
    buffer_store_dwordx4 v[116:119], v2, s[28:31], s26 offen offset:3072 sc1
    s_barrier
    s_mul_i32 s57, s3, 24576
    s_cmp_lt_u32 s3, 2
    s_cselect_b32 s21, 344064, 0
    s_add_u32 s19, s21, s54
    s_add_u32 m0, s57, 0x0
    s_add_u32 s20, s54, 0x30000
    buffer_load_dwordx4 v3, s[48:51], s20 offen lds
    s_add_u32 m0, s57, 0x2800
    s_add_u32 s20, s54, 0x30040
    buffer_load_dwordx4 v3, s[48:51], s20 offen lds
    s_add_u32 m0, s57, 0x400
    s_cbranch_execz L_disp
    s_add_u32 s20, s54, 0x34000
    buffer_load_dwordx4 v3, s[48:51], s20 offen lds
    s_add_u32 m0, s57, 0x2c00
    s_add_u32 s20, s54, 0x34040
    buffer_load_dwordx4 v3, s[48:51], s20 offen lds
    s_add_u32 m0, s57, 0x800
    s_add_u32 s20, s54, 0x38000
    buffer_load_dwordx4 v3, s[48:51], s20 offen lds
    s_add_u32 m0, s57, 0x3000
    s_add_u32 s20, s54, 0x38040
    buffer_load_dwordx4 v3, s[48:51], s20 offen lds
    s_cmp_ge_u32 s8, 11
    s_nop 0
    s_cbranch_scc1 L_no_t2
    v_pk_fma_f32 v[48:49], v[48:49], v[162:163], v[144:145] op_sel_hi:[1,0,1]
    v_pk_fma_f32 v[50:51], v[50:51], v[162:163], v[146:147] op_sel_hi:[1,0,1]
    v_pk_fma_f32 v[52:53], v[52:53], v[162:163], v[148:149] op_sel_hi:[1,0,1]
    v_pk_fma_f32 v[54:55], v[54:55], v[162:163], v[150:151] op_sel_hi:[1,0,1]
    v_pk_fma_f32 v[56:57], v[56:57], v[162:163], v[152:153] op_sel_hi:[1,0,1]
    v_pk_fma_f32 v[58:59], v[58:59], v[162:163], v[154:155] op_sel_hi:[1,0,1]
    v_pk_fma_f32 v[60:61], v[60:61], v[162:163], v[156:157] op_sel_hi:[1,0,1]
    v_pk_fma_f32 v[62:63], v[62:63], v[162:163], v[158:159] op_sel_hi:[1,0,1]
    v_exp_f32 v128, v48
    v_exp_f32 v129, v49
    v_exp_f32 v130, v50
    v_exp_f32 v131, v51
    v_exp_f32 v132, v52
    v_exp_f32 v133, v53
    v_exp_f32 v134, v54
    v_exp_f32 v135, v55
    v_exp_f32 v136, v56
    v_exp_f32 v137, v57
    v_exp_f32 v138, v58
    v_exp_f32 v139, v59
    v_exp_f32 v140, v60
    v_exp_f32 v141, v61
    v_exp_f32 v142, v62
    v_exp_f32 v143, v63
    v_pk_add_f32 v[128:129], v[128:129], 1.0 op_sel_hi:[1,0]
    v_pk_add_f32 v[130:131], v[130:131], 1.0 op_sel_hi:[1,0]
    v_pk_add_f32 v[132:133], v[132:133], 1.0 op_sel_hi:[1,0]
    s_cbranch_execz L_disp
    v_pk_add_f32 v[134:135], v[134:135], 1.0 op_sel_hi:[1,0]
    v_pk_add_f32 v[136:137], v[136:137], 1.0 op_sel_hi:[1,0]
    v_pk_add_f32 v[138:139], v[138:139], 1.0 op_sel_hi:[1,0]
    v_pk_add_f32 v[140:141], v[140:141], 1.0 op_sel_hi:[1,0]
    v_pk_add_f32 v[142:143], v[142:143], 1.0 op_sel_hi:[1,0]
    v_rcp_f32 v128, v128
    v_rcp_f32 v129, v129
    v_rcp_f32 v130, v130
    v_rcp_f32 v131, v131
    v_rcp_f32 v132, v132
    v_rcp_f32 v133, v133
    v_rcp_f32 v134, v134
    v_rcp_f32 v135, v135
    v_rcp_f32 v136, v136
    v_rcp_f32 v137, v137
    v_rcp_f32 v138, v138
    v_rcp_f32 v139, v139
    v_rcp_f32 v140, v140
    v_rcp_f32 v141, v141
    v_rcp_f32 v142, v142
    v_rcp_f32 v143, v143
    v_pk_mul_f32 v[48:49], v[48:49], v[128:129]
    v_pk_mul_f32 v[50:51], v[50:51], v[130:131]
    v_pk_mul_f32 v[52:53], v[52:53], v[132:133]
    v_pk_mul_f32 v[54:55], v[54:55], v[134:135]
    v_pk_mul_f32 v[56:57], v[56:57], v[136:137]
    v_pk_mul_f32 v[58:59], v[58:59], v[138:139]
    v_pk_mul_f32 v[60:61], v[60:61], v[140:141]
    v_pk_mul_f32 v[62:63], v[62:63], v[142:143]
    v_cvt_pk_bf16_f32 v144, v48, v49
    v_cvt_pk_bf16_f32 v145, v50, v51
    v_cvt_pk_bf16_f32 v146, v52, v53
    v_cvt_pk_bf16_f32 v147, v54, v55
    v_cvt_pk_bf16_f32 v148, v56, v57
    v_cvt_pk_bf16_f32 v149, v58, v59
    v_cvt_pk_bf16_f32 v150, v60, v61
    v_cvt_pk_bf16_f32 v151, v62, v63
    s_add_u32 s26, s26, 4096
    buffer_store_dwordx4 v[144:147], v2, s[28:31], s26 offen offset:0 sc1
    s_nop 0
    s_cbranch_execz L_disp
    buffer_store_dwordx4 v[148:151], v2, s[28:31], s26 offen offset:1024 sc1
L_no_t2:
    s_lshl_b32 s21, s9, 6
    s_lshl_b32 s22, s8, 2
    s_add_u32 s21, s21, s22
    s_add_u32 s21, s21, 0x6000
    s_mul_i32 s58, s10, 176128
    s_lshl_b32 s27, s55, 10
    s_add_u32 s58, s58, s27
    s_add_u32 s58, s58, 0x800000
    s_add_u32 s59, s58, 88064
    v_add_u32 v12, s57, v253
    v_add_u32 v13, s57, v2
    s_waitcnt vmcnt(0)
    s_mov_b64 exec, 1
    buffer_store_dword v254, off, s[28:31], s21
    s_add_u32 s21, s21, 0x8000
    buffer_store_dword v254, off, s[28:31], s21 sc1
    s_mov_b64 exec, -1
    s_add_u32 m0, s57, 0xc00
    s_add_u32 s20, s54, 0x3c000
    buffer_load_dwordx4 v3, s[48:51], s20 offen lds
    s_add_u32 m0, s57, 0x3400
    s_add_u32 s20, s54, 0x3c040
    buffer_load_dwordx4 v3, s[48:51], s20 offen lds
    s_add_u32 m0, s57, 0x1000
    s_add_u32 s20, s54, 0x40000
    buffer_load_dwordx4 v3, s[48:51], s20 offen lds
    s_add_u32 m0, s57, 0x3800
    s_add_u32 s20, s54, 0x40040
    buffer_load_dwordx4 v3, s[48:51], s20 offen lds
    s_add_u32 m0, s57, 0x1400
    s_add_u32 s20, s54, 0x44000
    buffer_load_dwordx4 v3, s[48:51], s20 offen lds
    s_add_u32 m0, s57, 0x3c00
    s_add_u32 s20, s54, 0x44040
    buffer_load_dwordx4 v3, s[48:51], s20 offen lds
    s_nop 0
    s_cbranch_execz L_disp
    s_add_u32 m0, s57, 0x1800
    s_add_u32 s20, s54, 0x48000
    buffer_load_dwordx4 v3, s[48:51], s20 offen lds
    s_add_u32 m0, s57, 0x4000
    s_add_u32 s20, s54, 0x48040
    buffer_load_dwordx4 v3, s[48:51], s20 offen lds
    s_add_u32 m0, s57, 0x1c00
    s_add_u32 s20, s54, 0x4c000
    buffer_load_dwordx4 v3, s[48:51], s20 offen lds
    s_add_u32 m0, s57, 0x4400
    s_add_u32 s20, s54, 0x4c040
    buffer_load_dwordx4 v3, s[48:51], s20 offen lds
    s_add_u32 m0, s57, 0x2000
    s_add_u32 s20, s54, 0x50000
    buffer_load_dwordx4 v3, s[48:51], s20 offen lds
    s_add_u32 m0, s57, 0x4800
    s_add_u32 s20, s54, 0x50040
    buffer_load_dwordx4 v3, s[48:51], s20 offen lds
    s_add_u32 m0, s57, 0x2400
    s_add_u32 s20, s19, 0x0
    buffer_load_dwordx4 v3, s[48:51], s20 offen lds
    s_add_u32 m0, s57, 0x4c00
    s_add_u32 s20, s19, 0x40
    buffer_load_dwordx4 v3, s[48:51], s20 offen lds
    v_accvgpr_read_b32 v104, a224
    v_accvgpr_read_b32 v105, a225
    v_accvgpr_read_b32 v106, a226
    v_accvgpr_read_b32 v107, a227
    v_accvgpr_read_b32 v108, a228
    v_accvgpr_read_b32 v109, a229
    v_accvgpr_read_b32 v110, a230
    v_accvgpr_read_b32 v111, a231
    s_nop 0
    s_cbranch_execz L_disp
    v_accvgpr_read_b32 v112, a232
    v_accvgpr_read_b32 v113, a233
    v_accvgpr_read_b32 v114, a234
    v_accvgpr_read_b32 v115, a235
    v_accvgpr_read_b32 v116, a236
    v_accvgpr_read_b32 v117, a237
    v_accvgpr_read_b32 v118, a238
    v_accvgpr_read_b32 v119, a239
    v_lshlrev_b32 v80, 16, v244
    v_and_b32 v81, 0xffff0000, v244
    v_lshlrev_b32 v82, 16, v245
    v_and_b32 v83, 0xffff0000, v245
    v_lshlrev_b32 v84, 16, v246
    v_and_b32 v85, 0xffff0000, v246
    v_lshlrev_b32 v86, 16, v247
    v_and_b32 v87, 0xffff0000, v247
    v_lshlrev_b32 v88, 16, v248
    v_and_b32 v89, 0xffff0000, v248
    v_lshlrev_b32 v90, 16, v249
    v_and_b32 v91, 0xffff0000, v249
    v_lshlrev_b32 v92, 16, v250
    v_and_b32 v93, 0xffff0000, v250
    v_lshlrev_b32 v94, 16, v251
    v_and_b32 v95, 0xffff0000, v251
    s_lshl_b32 s21, s10, 7
    s_add_u32 s21, s21, 0x6000
    s_mov_b32 exec_lo, 0xffffffff
    s_mov_b32 exec_hi, 0
    s_mov_b32 s17, 0
    s_add_u32 s18, s21, 0x8000
    s_cmp_eq_u32 s16, 0
    s_nop 0
    s_cbranch_scc1 ps_16
pf_15:
    buffer_load_dword v16, v14, s[28:31], s21 offen sc1
    s_add_u32 s17, s17, 1
    s_waitcnt vmcnt(0)
    v_cmp_ne_u32 vcc, s6, v16
    s_nop 4
    s_cbranch_vccz pd_17
    s_cmp_lt_u32 s17, s16
    s_cbranch_scc1 pf_15
ps_16:
    buffer_load_dword v16, v14, s[28:31], s21 offen sc1
    s_nop 0
    s_cbranch_execz L_disp
    buffer_load_dword v17, v14, s[28:31], s18 offen sc1
    s_add_u32 s17, s17, 1
    s_waitcnt vmcnt(0)
    v_cmp_ne_u32 s[22:23], s6, v16
    v_cmp_ne_u32 vcc, s6, v17
    s_nop 4
    s_and_b64 vcc, vcc, s[22:23]
    s_cmp_eq_u64 vcc, 0
    s_cbranch_scc1 pd_17
    s_cmp_lt_u32 s17, 30000
    s_cbranch_scc1 ps_16
pd_17:
    s_mov_b64 exec, -1
    s_cmp_ge_u32 s3, 2
    s_cbranch_scc1 L_noopt1
    s_add_u32 s26, s58, 21504
    s_add_u32 s27, s59, 21504
    buffer_load_dwordx4 a[212:215], v2, s[28:31], s26 offen sc1
    buffer_load_dwordx4 a[216:219], v2, s[28:31], s27 offen sc1
L_noopt1:
    buffer_load_dwordx4 a[0:3], v2, s[28:31], s58 offen offset:0 sc1
    buffer_load_dwordx4 a[4:7], v2, s[28:31], s59 offen offset:0 sc1
    buffer_load_dwordx4 a[8:11], v2, s[28:31], s58 offen offset:1024 sc1
    buffer_load_dwordx4 a[12:15], v2, s[28:31], s59 offen offset:1024 sc1
    buffer_load_dwordx4 a[16:19], v2, s[28:31], s58 offen offset:2048 sc1
    buffer_load_dwordx4 a[20:23], v2, s[28:31], s59 offen offset:2048 sc1
    buffer_load_dwordx4 a[24:27], v2, s[28:31], s58 offen offset:3072 sc1
    buffer_load_dwordx4 a[28:31], v2, s[28:31], s59 offen offset:3072 sc1
    s_add_u32 s58, s58, 4096
    s_add_u32 s59, s59, 4096
    buffer_load_dwordx4 a[32:35], v2, s[28:31], s58 offen offset:0 sc1
    buffer_load_dwordx4 a[36:39], v2, s[28:31], s59 offen offset:0 sc1
    v_mul_f32 v104, 0xbf317218, v104
    v_mul_f32 v105, 0xbf317218, v105
    v_mul_f32 v106, 0xbf317218, v106
    v_mul_f32 v107, 0xbf317218, v107
    v_mul_f32 v108, 0xbf317218, v108
    v_mul_f32 v109, 0xbf317218, v109
    v_mul_f32 v110, 0xbf317218, v110
    s_cbranch_execz L_disp
    v_mul_f32 v111, 0xbf317218, v111
    v_mul_f32 v112, 0xbf317218, v112
    v_mul_f32 v113, 0xbf317218, v113
    v_mul_f32 v114, 0xbf317218, v114
    v_mul_f32 v115, 0xbf317218, v115
    v_mul_f32 v116, 0xbf317218, v116
    v_mul_f32 v117, 0xbf317218, v117
    v_mul_f32 v118, 0xbf317218, v118
    v_mul_f32 v119, 0xbf317218, v119
    s_waitcnt vmcnt(8)
    v_mfma_f32_32x32x16_bf16 v[16:31], a[164:167], a[0:3], 0
    v_mfma_f32_32x32x16_bf16 v[48:63], a[188:191], a[0:3], 0
    buffer_load_dwordx4 a[40:43], v2, s[28:31], s58 offen offset:1024 sc1
    buffer_load_dwordx4 a[44:47], v2, s[28:31], s59 offen offset:1024 sc1
    v_mfma_f32_32x32x16_bf16 v[32:47], a[164:167], a[4:7], 0
    v_mfma_f32_32x32x16_bf16 v[64:79], a[188:191], a[4:7], 0
    buffer_load_dwordx4 a[48:51], v2, s[28:31], s58 offen offset:2048 sc1
    buffer_load_dwordx4 a[52:55], v2, s[28:31], s59 offen offset:2048 sc1
    s_waitcnt vmcnt(10)
    v_mfma_f32_32x32x16_bf16 v[16:31], a[168:171], a[8:11], v[16:31]
    v_mfma_f32_32x32x16_bf16 v[48:63], a[192:195], a[8:11], v[48:63]
    buffer_load_dwordx4 a[56:59], v2, s[28:31], s58 offen offset:3072 sc1
    buffer_load_dwordx4 a[60:63], v2, s[28:31], s59 offen offset:3072 sc1
    v_mfma_f32_32x32x16_bf16 v[32:47], a[168:171], a[12:15], v[32:47]
    v_mfma_f32_32x32x16_bf16 v[64:79], a[192:195], a[12:15], v[64:79]
    s_add_u32 s58, s58, 4096
    s_add_u32 s59, s59, 4096
    buffer_load_dwordx4 a[64:67], v2, s[28:31], s58 offen offset:0 sc1
    buffer_load_dwordx4 a[68:71], v2, s[28:31], s59 offen offset:0 sc1
    s_waitcnt vmcnt(12)
    v_mfma_f32_32x32x16_bf16 v[16:31], a[172:175], a[16:19], v[16:31]
    v_mfma_f32_32x32x16_bf16 v[48:63], a[196:199], a[16:19], v[48:63]
    buffer_load_dwordx4 a[72:75], v2, s[28:31], s58 offen offset:1024 sc1
    s_cbranch_execz L_disp
    buffer_load_dwordx4 a[76:79], v2, s[28:31], s59 offen offset:1024 sc1
    v_mfma_f32_32x32x16_bf16 v[32:47], a[172:175], a[20:23], v[32:47]
    v_mfma_f32_32x32x16_bf16 v[64:79], a[196:199], a[20:23], v[64:79]
    buffer_load_dwordx4 a[80:83], v2, s[28:31], s58 offen offset:2048 sc1
    buffer_load_dwordx4 a[84:87], v2, s[28:31], s59 offen offset:2048 sc1
    s_waitcnt vmcnt(14)
    v_mfma_f32_32x32x16_bf16 v[16:31], a[176:179], a[24:27], v[16:31]
    v_mfma_f32_32x32x16_bf16 v[48:63], a[200:203], a[24:27], v[48:63]
    buffer_load_dwordx4 a[88:91], v2, s[28:31], s58 offen offset:3072 sc1
    buffer_load_dwordx4 a[92:95], v2, s[28:31], s59 offen offset:3072 sc1
    v_mfma_f32_32x32x16_bf16 v[32:47], a[176:179], a[28:31], v[32:47]
    v_mfma_f32_32x32x16_bf16 v[64:79], a[200:203], a[28:31], v[64:79]
    s_add_u32 s58, s58, 4096
    s_add_u32 s59, s59, 4096
    buffer_load_dwordx4 a[96:99], v2, s[28:31], s58 offen offset:0 sc1
    buffer_load_dwordx4 a[100:103], v2, s[28:31], s59 offen offset:0 sc1
    s_waitcnt vmcnt(16)
    v_mfma_f32_32x32x16_bf16 v[16:31], a[180:183], a[32:35], v[16:31]
    buffer_load_dwordx4 a[104:107], v2, s[28:31], s58 offen offset:1024 sc1
    buffer_load_dwordx4 a[108:111], v2, s[28:31], s59 offen offset:1024 sc1
    v_mfma_f32_32x32x16_bf16 v[48:63], a[204:207], a[32:35], v[48:63]
    buffer_load_dwordx4 a[112:115], v2, s[28:31], s58 offen offset:2048 sc1
    buffer_load_dwordx4 a[116:119], v2, s[28:31], s59 offen offset:2048 sc1
    ds_read_b64_tr_b16 a[128:129], v11 offset:0
    v_mfma_f32_32x32x16_bf16 v[32:47], a[180:183], a[36:39], v[32:47]
    ds_read_b64_tr_b16 a[130:131], v11 offset:256
    v_mfma_f32_32x32x16_bf16 v[64:79], a[204:207], a[36:39], v[64:79]
    ds_read_b64_tr_b16 a[132:133], v11 offset:6144
    ds_read_b64_tr_b16 a[134:135], v11 offset:6400
    s_waitcnt vmcnt(18)
    v_mfma_f32_32x32x16_bf16 v[16:31], a[184:187], a[40:43], v[16:31]
    buffer_load_dwordx4 a[120:123], v2, s[28:31], s58 offen offset:3072 sc1
    buffer_load_dwordx4 a[124:127], v2, s[28:31], s59 offen offset:3072 sc1
    s_cbranch_execz L_disp
    v_mfma_f32_32x32x16_bf16 v[48:63], a[208:211], a[40:43], v[48:63]
    s_add_u32 s58, s58, 4096
    s_add_u32 s59, s59, 4096
    buffer_load_dwordx4 a[0:3], v2, s[28:31], s58 offen offset:0 sc1
    buffer_load_dwordx4 a[4:7], v2, s[28:31], s59 offen offset:0 sc1
    ds_read_b64_tr_b16 a[136:137], v11 offset:1024
    v_mfma_f32_32x32x16_bf16 v[32:47], a[184:187], a[44:47], v[32:47]
    ds_read_b64_tr_b16 a[138:139], v11 offset:1280
    v_mfma_f32_32x32x16_bf16 v[64:79], a[208:211], a[44:47], v[64:79]
    ds_read_b64_tr_b16 a[140:141], v11 offset:7168
    ds_read_b64_tr_b16 a[142:143], v11 offset:7424
    s_waitcnt lgkmcnt(4)
    s_waitcnt vmcnt(20)
    v_mfma_f32_32x32x16_bf16 v[16:31], a[128:131], a[48:51], v[16:31]
    buffer_load_dwordx4 a[8:11], v2, s[28:31], s58 offen offset:1024 sc1
    buffer_load_dwordx4 a[12:15], v2, s[28:31], s59 offen offset:1024 sc1
    v_mfma_f32_32x32x16_bf16 v[48:63], a[132:135], a[48:51], v[48:63]
    buffer_load_dwordx4 a[16:19], v2, s[28:31], s58 offen offset:2048 sc1
    buffer_load_dwordx4 a[20:23], v2, s[28:31], s59 offen offset:2048 sc1
    ds_read_b64_tr_b16 a[144:145], v11 offset:2048
    v_mfma_f32_32x32x16_bf16 v[32:47], a[128:131], a[52:55], v[32:47]
    ds_read_b64_tr_b16 a[146:147], v11 offset:2304
    v_mfma_f32_32x32x16_bf16 v[64:79], a[132:135], a[52:55], v[64:79]
    ds_read_b64_tr_b16 a[148:149], v11 offset:8192
    ds_read_b64_tr_b16 a[150:151], v11 offset:8448
    s_waitcnt lgkmcnt(4)
    s_waitcnt vmcnt(22)
    v_mfma_f32_32x32x16_bf16 v[16:31], a[136:139], a[56:59], v[16:31]
    buffer_load_dwordx4 a[24:27], v2, s[28:31], s58 offen offset:3072 sc1
    buffer_load_dwordx4 a[28:31], v2, s[28:31], s59 offen offset:3072 sc1
    v_mfma_f32_32x32x16_bf16 v[48:63], a[140:143], a[56:59], v[48:63]
    s_add_u32 s58, s58, 4096
    s_add_u32 s59, s59, 4096
    s_nop 0
    s_cbranch_execz L_disp
    buffer_load_dwordx4 a[32:35], v2, s[28:31], s58 offen offset:0 sc1
    buffer_load_dwordx4 a[36:39], v2, s[28:31], s59 offen offset:0 sc1
    ds_read_b64_tr_b16 a[128:129], v11 offset:3072
    v_mfma_f32_32x32x16_bf16 v[32:47], a[136:139], a[60:63], v[32:47]
    ds_read_b64_tr_b16 a[130:131], v11 offset:3328
    v_mfma_f32_32x32x16_bf16 v[64:79], a[140:143], a[60:63], v[64:79]
    ds_read_b64_tr_b16 a[132:133], v11 offset:9216
    ds_read_b64_tr_b16 a[134:135], v11 offset:9472
    s_waitcnt lgkmcnt(4)
    s_waitcnt vmcnt(24)
    v_mfma_f32_32x32x16_bf16 v[16:31], a[144:147], a[64:67], v[16:31]
    ds_read_b64_tr_b16 a[136:137], v11 offset:4096
    v_mfma_f32_32x32x16_bf16 v[48:63], a[148:151], a[64:67], v[48:63]
    ds_read_b64_tr_b16 a[138:139], v11 offset:4352
    v_mfma_f32_32x32x16_bf16 v[32:47], a[144:147], a[68:71], v[32:47]
    ds_read_b64_tr_b16 a[140:141], v11 offset:10240
    v_mfma_f32_32x32x16_bf16 v[64:79], a[148:151], a[68:71], v[64:79]
    ds_read_b64_tr_b16 a[142:143], v11 offset:10496
    s_waitcnt lgkmcnt(4)
    s_waitcnt vmcnt(22)
    v_mfma_f32_32x32x16_bf16 v[16:31], a[128:131], a[72:75], v[16:31]
    ds_read_b64_tr_b16 a[144:145], v11 offset:5120
    v_mfma_f32_32x32x16_bf16 v[48:63], a[132:135], a[72:75], v[48:63]
    ds_read_b64_tr_b16 a[146:147], v11 offset:5376
    v_mfma_f32_32x32x16_bf16 v[32:47], a[128:131], a[76:79], v[32:47]
    ds_read_b64_tr_b16 a[148:149], v11 offset:11264
    v_mfma_f32_32x32x16_bf16 v[64:79], a[132:135], a[76:79], v[64:79]
    ds_read_b64_tr_b16 a[150:151], v11 offset:11520
    s_waitcnt lgkmcnt(4)
    s_waitcnt vmcnt(20)
    v_mfma_f32_32x32x16_bf16 v[16:31], a[136:139], a[80:83], v[16:31]
    ds_read_b64_tr_b16 a[128:129], v12 offset:0
    v_mfma_f32_32x32x16_bf16 v[48:63], a[140:143], a[80:83], v[48:63]
    ds_read_b64_tr_b16 a[130:131], v12 offset:256
    s_nop 0
    s_cbranch_execz L_disp
    v_mfma_f32_32x32x16_bf16 v[32:47], a[136:139], a[84:87], v[32:47]
    ds_read_b64_tr_b16 a[132:133], v12 offset:10240
    v_mfma_f32_32x32x16_bf16 v[64:79], a[140:143], a[84:87], v[64:79]
    ds_read_b64_tr_b16 a[134:135], v12 offset:10496
    s_waitcnt lgkmcnt(4)
    s_waitcnt vmcnt(18)
    v_mfma_f32_32x32x16_bf16 v[16:31], a[144:147], a[88:91], v[16:31]
    ds_read_b64_tr_b16 a[136:137], v12 offset:1024
    v_mfma_f32_32x32x16_bf16 v[48:63], a[148:151], a[88:91], v[48:63]
    ds_read_b64_tr_b16 a[138:139], v12 offset:1280
    v_mfma_f32_32x32x16_bf16 v[32:47], a[144:147], a[92:95], v[32:47]
    ds_read_b64_tr_b16 a[140:141], v12 offset:11264
    v_mfma_f32_32x32x16_bf16 v[64:79], a[148:151], a[92:95], v[64:79]
    ds_read_b64_tr_b16 a[142:143], v12 offset:11520
    s_waitcnt lgkmcnt(4)
    s_waitcnt vmcnt(16)
    v_mfma_f32_32x32x16_bf16 v[16:31], a[128:131], a[96:99], v[16:31]
    ds_read_b64_tr_b16 a[144:145], v12 offset:2048
    v_mfma_f32_32x32x16_bf16 v[48:63], a[132:135], a[96:99], v[48:63]
    ds_read_b64_tr_b16 a[146:147], v12 offset:2304
    v_mfma_f32_32x32x16_bf16 v[32:47], a[128:131], a[100:103], v[32:47]
    ds_read_b64_tr_b16 a[148:149], v12 offset:12288
    v_mfma_f32_32x32x16_bf16 v[64:79], a[132:135], a[100:103], v[64:79]
    ds_read_b64_tr_b16 a[150:151], v12 offset:12544
    s_waitcnt lgkmcnt(4)
    s_waitcnt vmcnt(14)
    v_mfma_f32_32x32x16_bf16 v[16:31], a[136:139], a[104:107], v[16:31]
    ds_read_b64_tr_b16 a[128:129], v12 offset:3072
    v_mfma_f32_32x32x16_bf16 v[48:63], a[140:143], a[104:107], v[48:63]
    ds_read_b64_tr_b16 a[130:131], v12 offset:3328
    v_mfma_f32_32x32x16_bf16 v[32:47], a[136:139], a[108:111], v[32:47]
    ds_read_b64_tr_b16 a[132:133], v12 offset:13312
    v_mfma_f32_32x32x16_bf16 v[64:79], a[140:143], a[108:111], v[64:79]
    ds_read_b64_tr_b16 a[134:135], v12 offset:13568
    s_waitcnt lgkmcnt(4)
    s_cbranch_execz L_disp
    s_waitcnt vmcnt(12)
    v_mfma_f32_32x32x16_bf16 v[16:31], a[144:147], a[112:115], v[16:31]
    ds_read_b64_tr_b16 a[136:137], v12 offset:4096
    v_mfma_f32_32x32x16_bf16 v[48:63], a[148:151], a[112:115], v[48:63]
    ds_read_b64_tr_b16 a[138:139], v12 offset:4352
    v_mfma_f32_32x32x16_bf16 v[32:47], a[144:147], a[116:119], v[32:47]
    ds_read_b64_tr_b16 a[140:141], v12 offset:14336
    v_mfma_f32_32x32x16_bf16 v[64:79], a[148:151], a[116:119], v[64:79]
    ds_read_b64_tr_b16 a[142:143], v12 offset:14592
    s_waitcnt lgkmcnt(4)
    s_waitcnt vmcnt(10)
    v_mfma_f32_32x32x16_bf16 v[16:31], a[128:131], a[120:123], v[16:31]
    ds_read_b64_tr_b16 a[144:145], v12 offset:5120
    v_mfma_f32_32x32x16_bf16 v[48:63], a[132:135], a[120:123], v[48:63]
    ds_read_b64_tr_b16 a[146:147], v12 offset:5376
    v_mfma_f32_32x32x16_bf16 v[32:47], a[128:131], a[124:127], v[32:47]
    ds_read_b64_tr_b16 a[148:149], v12 offset:15360
    v_mfma_f32_32x32x16_bf16 v[64:79], a[132:135], a[124:127], v[64:79]
    ds_read_b64_tr_b16 a[150:151], v12 offset:15616
    s_waitcnt lgkmcnt(4)
    s_waitcnt vmcnt(8)
    v_mfma_f32_32x32x16_bf16 v[16:31], a[136:139], a[0:3], v[16:31]
    ds_read_b64_tr_b16 a[128:129], v12 offset:6144
    v_mfma_f32_32x32x16_bf16 v[48:63], a[140:143], a[0:3], v[48:63]
    ds_read_b64_tr_b16 a[130:131], v12 offset:6400
    v_mfma_f32_32x32x16_bf16 v[32:47], a[136:139], a[4:7], v[32:47]
    ds_read_b64_tr_b16 a[132:133], v12 offset:16384
    v_mfma_f32_32x32x16_bf16 v[64:79], a[140:143], a[4:7], v[64:79]
    ds_read_b64_tr_b16 a[134:135], v12 offset:16640
    s_waitcnt lgkmcnt(4)
    s_waitcnt vmcnt(6)
    v_mfma_f32_32x32x16_bf16 v[16:31], a[144:147], a[8:11], v[16:31]
    ds_read_b64_tr_b16 a[136:137], v12 offset:7168
    v_mfma_f32_32x32x16_bf16 v[48:63], a[148:151], a[8:11], v[48:63]
    ds_read_b64_tr_b16 a[138:139], v12 offset:7424
    s_cbranch_execz L_disp
    v_mfma_f32_32x32x16_bf16 v[32:47], a[144:147], a[12:15], v[32:47]
    ds_read_b64_tr_b16 a[140:141], v12 offset:17408
    v_mfma_f32_32x32x16_bf16 v[64:79], a[148:151], a[12:15], v[64:79]
    ds_read_b64_tr_b16 a[142:143], v12 offset:17664
    s_waitcnt lgkmcnt(4)
    s_waitcnt vmcnt(4)
    v_mfma_f32_32x32x16_bf16 v[16:31], a[128:131], a[16:19], v[16:31]
    ds_read_b64_tr_b16 a[144:145], v12 offset:8192
    v_mfma_f32_32x32x16_bf16 v[48:63], a[132:135], a[16:19], v[48:63]
    ds_read_b64_tr_b16 a[146:147], v12 offset:8448
    v_mfma_f32_32x32x16_bf16 v[32:47], a[128:131], a[20:23], v[32:47]
    ds_read_b64_tr_b16 a[148:149], v12 offset:18432
    v_mfma_f32_32x32x16_bf16 v[64:79], a[132:135], a[20:23], v[64:79]
    ds_read_b64_tr_b16 a[150:151], v12 offset:18688
    s_waitcnt lgkmcnt(4)
    s_waitcnt vmcnt(2)
    v_mfma_f32_32x32x16_bf16 v[16:31], a[136:139], a[24:27], v[16:31]
    ds_read_b64_tr_b16 a[128:129], v12 offset:9216
    v_mfma_f32_32x32x16_bf16 v[48:63], a[140:143], a[24:27], v[48:63]
    ds_read_b64_tr_b16 a[130:131], v12 offset:9472
    v_mfma_f32_32x32x16_bf16 v[32:47], a[136:139], a[28:31], v[32:47]
    ds_read_b64_tr_b16 a[132:133], v12 offset:19456
    v_mfma_f32_32x32x16_bf16 v[64:79], a[140:143], a[28:31], v[64:79]
    ds_read_b64_tr_b16 a[134:135], v12 offset:19712
    s_waitcnt lgkmcnt(4)
    s_waitcnt vmcnt(0)
    v_mfma_f32_32x32x16_bf16 v[16:31], a[144:147], a[32:35], v[16:31]
    v_mfma_f32_32x32x16_bf16 v[48:63], a[148:151], a[32:35], v[48:63]
    v_mfma_f32_32x32x16_bf16 v[32:47], a[144:147], a[36:39], v[32:47]
    v_mfma_f32_32x32x16_bf16 v[64:79], a[148:151], a[36:39], v[64:79]
    s_waitcnt lgkmcnt(0)
    s_cmp_ge_u32 s3, 2
    s_nop 9
    s_cbranch_scc1 L_noopt2
    v_mfma_f32_32x32x16_bf16 v[16:31], a[128:131], a[212:215], v[16:31]
    v_mfma_f32_32x32x16_bf16 v[48:63], a[132:135], a[212:215], v[48:63]
    s_nop 0
    s_cbranch_execz L_disp
    v_mfma_f32_32x32x16_bf16 v[32:47], a[128:131], a[216:219], v[32:47]
    v_mfma_f32_32x32x16_bf16 v[64:79], a[132:135], a[216:219], v[64:79]
L_noopt2:
    s_nop 11
    ds_write_b128 v13, v[16:19] offset:0
    ds_write_b128 v13, v[20:23] offset:1024
    ds_write_b128 v13, v[24:27] offset:2048
    ds_write_b128 v13, v[28:31] offset:3072
    ds_write_b128 v13, v[32:35] offset:4096
    ds_write_b128 v13, v[36:39] offset:5120
    ds_write_b128 v13, v[40:43] offset:6144
    ds_write_b128 v13, v[44:47] offset:7168
    ds_write_b128 v13, v[48:51] offset:8192
    ds_write_b128 v13, v[52:55] offset:9216
    ds_write_b128 v13, v[56:59] offset:10240
    ds_write_b128 v13, v[60:63] offset:11264
    ds_write_b128 v13, v[64:67] offset:12288
    ds_write_b128 v13, v[68:71] offset:13312
    ds_write_b128 v13, v[72:75] offset:14336
    ds_write_b128 v13, v[76:79] offset:15360
    s_lshl_b32 s26, s3, 12
    v_add_u32 v13, s26, v2
    v_add_u32 v12, 49152, v13
    s_waitcnt lgkmcnt(0)
    s_barrier
    ds_read_b128 v[16:19], v13 offset:0
    ds_read_b128 v[20:23], v13 offset:1024
    ds_read_b128 v[24:27], v13 offset:2048
    ds_read_b128 v[28:31], v13 offset:3072
    ds_read_b128 v[32:35], v13 offset:24576
    ds_read_b128 v[36:39], v13 offset:25600
    ds_read_b128 v[40:43], v13 offset:26624
    ds_read_b128 v[44:47], v13 offset:27648
    ds_read_b128 v[48:51], v12 offset:0
    ds_read_b128 v[52:55], v12 offset:1024
    s_cbranch_execz L_disp
    ds_read_b128 v[56:59], v12 offset:2048
    ds_read_b128 v[60:63], v12 offset:3072
    ds_read_b128 v[64:67], v12 offset:24576
    ds_read_b128 v[68:71], v12 offset:25600
    ds_read_b128 v[72:75], v12 offset:26624
    ds_read_b128 v[76:79], v12 offset:27648
    s_waitcnt lgkmcnt(8)
    v_pk_add_f32 v[16:17], v[16:17], v[32:33]
    v_pk_add_f32 v[18:19], v[18:19], v[34:35]
    v_pk_add_f32 v[20:21], v[20:21], v[36:37]
    v_pk_add_f32 v[22:23], v[22:23], v[38:39]
    v_pk_add_f32 v[24:25], v[24:25], v[40:41]
    v_pk_add_f32 v[26:27], v[26:27], v[42:43]
    v_pk_add_f32 v[28:29], v[28:29], v[44:45]
    v_pk_add_f32 v[30:31], v[30:31], v[46:47]
    s_waitcnt lgkmcnt(0)
    v_pk_add_f32 v[48:49], v[48:49], v[64:65]
    v_pk_add_f32 v[50:51], v[50:51], v[66:67]
    v_pk_add_f32 v[52:53], v[52:53], v[68:69]
    v_pk_add_f32 v[54:55], v[54:55], v[70:71]
    v_pk_add_f32 v[56:57], v[56:57], v[72:73]
    v_pk_add_f32 v[58:59], v[58:59], v[74:75]
    v_pk_add_f32 v[60:61], v[60:61], v[76:77]
    v_pk_add_f32 v[62:63], v[62:63], v[78:79]
    v_pk_add_f32 v[16:17], v[16:17], v[48:49]
    v_pk_add_f32 v[18:19], v[18:19], v[50:51]
    v_pk_add_f32 v[20:21], v[20:21], v[52:53]
    v_pk_add_f32 v[22:23], v[22:23], v[54:55]
    v_pk_add_f32 v[24:25], v[24:25], v[56:57]
    v_pk_add_f32 v[26:27], v[26:27], v[58:59]
    v_pk_add_f32 v[28:29], v[28:29], v[60:61]
    v_pk_add_f32 v[30:31], v[30:31], v[62:63]
    s_nop 0
    s_cbranch_execz L_disp
    v_pk_fma_f32 v[16:17], v[16:17], v[104:105], v[80:81]
    v_pk_fma_f32 v[18:19], v[18:19], v[106:107], v[82:83]
    v_pk_fma_f32 v[20:21], v[20:21], v[108:109], v[84:85]
    v_pk_fma_f32 v[22:23], v[22:23], v[110:111], v[86:87]
    v_pk_fma_f32 v[24:25], v[24:25], v[112:113], v[88:89]
    v_pk_fma_f32 v[26:27], v[26:27], v[114:115], v[90:91]
    v_pk_fma_f32 v[28:29], v[28:29], v[116:117], v[92:93]
    v_pk_fma_f32 v[30:31], v[30:31], v[118:119], v[94:95]
    v_cvt_pk_bf16_f32 v32, v16, v17
    v_cvt_pk_bf16_f32 v33, v18, v19
    v_cvt_pk_bf16_f32 v34, v20, v21
    v_cvt_pk_bf16_f32 v35, v22, v23
    v_cvt_pk_bf16_f32 v36, v24, v25
    v_cvt_pk_bf16_f32 v37, v26, v27
    v_cvt_pk_bf16_f32 v38, v28, v29
    v_cvt_pk_bf16_f32 v39, v30, v31
    buffer_store_dwordx4 v[32:35], v7, s[92:95], s52 offen
    buffer_store_dwordx4 v[36:39], v7, s[92:95], s52 offen offset:32
    s_or_b32 s21, s2, s3
    s_cmp_lg_u32 s21, 0
    s_nop 0
    s_cbranch_scc1 L_noepoch
    s_mov_b64 exec, 1
    buffer_store_dword v254, off, s[28:31], 0 sc1
    s_mov_b64 exec, -1
L_noepoch:
    s_endpgm
.section .rodata,"a"
.p2align 6
.amdhsa_kernel adaLN_cond__sliding_local_dilated__dense_activation_silu__prompt_kernel
  .amdhsa_next_free_vgpr 512
  .amdhsa_next_free_sgpr 102
  .amdhsa_accum_offset 256
  .amdhsa_group_segment_fixed_size 0
  .amdhsa_kernarg_size 88
  .amdhsa_user_sgpr_count 2
  .amdhsa_user_sgpr_kernarg_segment_ptr 1
  .amdhsa_system_sgpr_workgroup_id_x 1
.end_amdhsa_kernel
```
